```python
import torch

def _softmax(x, axis=-1):
    return torch.softmax(x, dim=axis)
def _gelu(x):
    return torch.nn.functional.gelu(x, approximate="tanh")
def _silu(x):
    return torch.nn.functional.silu(x)
def _sigmoid(x):
    return torch.sigmoid(x)
def _layernorm(x, axis=-1, eps=1e-5):
    m = x.mean(dim=axis, keepdim=True)
    v = x.var(dim=axis, keepdim=True, unbiased=False)
    return (x - m) / torch.sqrt(v + eps)
def _scatter_add(tgt, idx, src, axis=0):
    return tgt.clone().index_add_(axis, idx, src)
def _segment_sum(src, seg, n):
    out = torch.zeros((n,) + src.shape[1:], dtype=src.dtype)
    return out.index_add_(0, seg, src)
def _pad(x, pw):
    flat = tuple(v for pair in reversed(pw) for v in pair)
    return torch.nn.functional.pad(x, flat)

kernel_name = 'standalone__glu_gated_glu__prompt'

def setup_inputs():

    _w = (lambda a: (lambda t: t.to(torch.bfloat16) if t.is_floating_point() else t)(torch.as_tensor(a)))
    B, S, D, F = 1, 2048, 640, 1536
    return {
        "x": _w((lambda *s: torch.randn(*s, dtype=torch.bfloat16) * 0.2)(B, S, D)),
        "w_gate": _w((lambda *s: torch.randn(*s, dtype=torch.bfloat16) * 0.2)(D, F)),
        "w_up": _w((lambda *s: torch.randn(*s, dtype=torch.bfloat16) * 0.05)(D, F)),
        "w_down": _w((lambda *s: torch.randn(*s, dtype=torch.bfloat16) * 0.05)(F, D)),
    }

def reference(x, w_gate, w_up, w_down):
    g = torch.einsum("bsd,df->bsf", x, w_gate)
    u = torch.einsum("bsd,df->bsf", x, w_up)
    h = _sigmoid(g) * u
    return torch.einsum("bsf,fd->bsd", h, w_down)
```

```asm
; @launch grid=(256,1,1) block=(512,1,1) lds=163840
.amdgcn_target "amdgcn-amd-amdhsa--gfx950"
.text
.globl standalone__glu_gated_glu__prompt_kernel
.p2align 8
.type standalone__glu_gated_glu__prompt_kernel,@function
standalone__glu_gated_glu__prompt_kernel:
    s_load_dwordx2 s[16:17], s[0:1], 0
    s_load_dwordx2 s[20:21], s[0:1], 8
    s_load_dwordx2 s[24:25], s[0:1], 16
    s_load_dwordx2 s[10:11], s[0:1], 24
    s_load_dwordx4 s[12:15], s[0:1], 32
    s_load_dwordx2 s[36:37], s[0:1], 48
    s_cmp_ge_u32 s2, 256
    s_cbranch_scc1 L_end
    v_and_b32 v1, 63, v0
    v_lshrrev_b32 v2, 6, v0
    s_and_b32 s40, s2, 7
    s_lshr_b32 s41, s2, 3
    v_readfirstlane_b32 s38, v2
    s_and_b32 s60, s40, 1
    s_lshl_b32 s60, s60, 3
    s_and_b32 s42, s41, 7
    s_add_u32 s60, s60, s42
    s_lshr_b32 s61, s40, 1
    s_lshl_b32 s61, s61, 2
    s_lshr_b32 s43, s41, 3
    s_add_u32 s61, s61, s43
    s_lshl_b32 s64, s61, 1
    s_add_u32 s64, s64, s60
    s_and_b32 s64, s64, 7
    s_cmp_lt_u32 s38, 4
    s_cbranch_scc1 L_compute
    s_sub_u32 s39, s38, 4
    v_lshrrev_b32 v10, 3, v1
    v_and_b32 v11, 7, v1
    v_lshrrev_b32 v12, 4, v1
    v_xor_b32 v13, v11, v12
    v_xor_b32 v14, 4, v13
    s_lshl_b32 s46, s60, 7
    s_lshl_b32 s47, s39, 5
    s_add_u32 s46, s46, s47
    s_mul_i32 s46, s46, 1280
    v_mul_u32_u24 v10, 1280, v10
    v_add_u32 v10, s46, v10
    v_lshlrev_b32 v13, 4, v13
    v_lshlrev_b32 v14, 4, v14
    v_add_u32 v2, v10, v13
    v_add_u32 v3, v10, v14
    v_add_u32 v4, 18432, v2
    v_add_u32 v5, 27648, v3
    v_add_u32 v3, 9216, v3
    s_mul_i32 s46, s61, 192
    s_mul_i32 s47, s39, 16*3072
    s_add_u32 s46, s46, s47
    v_add_u32 v10, 0, v1
    v_mul_u32_u24 v11, 171, v10
    v_lshrrev_b32 v11, 11, v11
    v_mul_u32_u24 v12, 12, v11
    v_sub_u32 v12, v10, v12
    v_mul_u32_u24 v13, 3072, v11
    v_add_u32 v13, s46, v13
    v_lshlrev_b32 v12, 4, v12
    v_and_b32 v14, 8, v11
    v_lshlrev_b32 v14, 2, v14
    v_xor_b32 v12, v12, v14
    v_add_u32 v6, v13, v12
    v_add_u32 v10, 64, v1
    v_mul_u32_u24 v11, 171, v10
    v_lshrrev_b32 v11, 11, v11
    v_mul_u32_u24 v12, 12, v11
    v_sub_u32 v12, v10, v12
    v_mul_u32_u24 v13, 3072, v11
    v_add_u32 v13, s46, v13
    v_subrev_u32 v13, 1024, v13
    v_lshlrev_b32 v12, 4, v12
    v_and_b32 v14, 8, v11
    v_lshlrev_b32 v14, 2, v14
    v_xor_b32 v12, v12, v14
    v_add_u32 v7, v13, v12
    v_add_u32 v10, 128, v1
    v_mul_u32_u24 v11, 171, v10
    v_lshrrev_b32 v11, 11, v11
    v_mul_u32_u24 v12, 12, v11
    v_sub_u32 v12, v10, v12
    v_mul_u32_u24 v13, 3072, v11
    v_add_u32 v13, s46, v13
    v_subrev_u32 v13, 2048, v13
    v_lshlrev_b32 v12, 4, v12
    v_and_b32 v14, 8, v11
    v_lshlrev_b32 v14, 2, v14
    v_xor_b32 v12, v12, v14
    v_add_u32 v8, v13, v12
    s_lshl_b32 s48, s39, 12
    s_mul_i32 s49, s39, 3072
    s_add_u32 s49, s49, 16384
    s_add_u32 s50, s49, 12288
    s_mul_i32 s55, s64, 10
    s_lshr_b32 s55, s55, 3
    s_mov_b32 s18, 2621440
    s_mov_b32 s19, 0x20000
    s_mov_b32 s22, 1966080
    s_mov_b32 s23, 0x20000
    s_mov_b32 s26, 1966080
    s_mov_b32 s27, 0x20000
    s_add_u32 s56, s55, 0
    s_sub_u32 s57, s56, 10
    s_cmp_ge_u32 s56, 10
    s_cselect_b32 s56, s57, s56
    s_lshl_b32 s51, s56, 7
    s_mul_i32 s52, s56, 64*3072
    s_add_u32 m0, s48, 0
    s_waitcnt lgkmcnt(0)
    buffer_load_dwordx4 v2, s[16:19], s51 offen offset:0 lds
    buffer_load_dwordx4 v3, s[16:19], s51 offen offset:1024 lds
    buffer_load_dwordx4 v4, s[16:19], s51 offen offset:2048 lds
    buffer_load_dwordx4 v5, s[16:19], s51 offen offset:3072 lds
    s_add_u32 m0, s49, 0
    s_nop 0
    buffer_load_dwordx4 v6, s[20:23], s52 offen offset:0 lds
    buffer_load_dwordx4 v7, s[20:23], s52 offen offset:1024 lds
    buffer_load_dwordx4 v8, s[20:23], s52 offen offset:2048 lds
    s_add_u32 m0, s50, 0
    s_nop 0
    buffer_load_dwordx4 v6, s[24:27], s52 offen offset:0 lds
    buffer_load_dwordx4 v7, s[24:27], s52 offen offset:1024 lds
    buffer_load_dwordx4 v8, s[24:27], s52 offen offset:2048 lds
    s_mov_b32 s32, s36
    s_mov_b32 s33, s37
    s_mov_b32 s34, 268435456
    s_mov_b32 s35, 0x20000
    s_mov_b32 s72, s14
    s_mov_b32 s73, s15
    s_mov_b32 s74, 256
    s_mov_b32 s75, 0x20000
    s_lshl_b32 s62, s40, 2
    s_add_u32 s62, s62, s43
    s_mov_b32 s63, s42
    s_lshr_b32 s44, s64, 2
    s_lshl_b32 s45, s43, 1
    s_add_u32 s45, s45, s44
    s_lshl_b32 s46, s45, 1
    s_and_b32 s47, s64, 1
    s_add_u32 s46, s46, s47
    s_add_u32 s45, s45, 16
    s_bitcmp1_b32 s64, 1
    s_cselect_b32 s67, s45, s46
    s_and_b32 s47, s64, 3
    s_cmp_eq_u32 s47, 3
    s_cselect_b32 s67, 255, s67
    s_mov_b32 s89, 0
    s_lshr_b32 s46, s39, 1
    s_mul_i32 s46, s46, 24
    s_and_b32 s47, s39, 1
    s_lshl_b32 s47, s47, 1
    s_add_u32 s46, s46, s47
    s_mul_i32 s47, s63, 48
    s_add_u32 s46, s46, s47
    s_mul_i32 s46, s46, 5120
    s_add_u32 s46, s46, 8388608
    v_lshlrev_b32 v16, 4, v1
    v_add_u32 v16, s46, v16
    v_add_u32 v17, 4096, v16
    v_add_u32 v18, 8192, v16
    s_mul_i32 s53, s39, 10240
    v_min_u32 v19, 23, v1
    v_lshlrev_b32 v19, 7, v19
    s_lshl_b32 s46, s63, 12
    s_add_u32 s46, s46, 7864320
    v_add_u32 v19, s46, v19
    v_mov_b32 v20, 0
    v_mov_b32 v25, 0
    s_lshl_b32 s46, s40, 5
    s_add_u32 s46, s46, s67
    s_lshl_b32 s46, s46, 7
    s_add_u32 s46, s46, 7864320
    v_and_b32 v27, 31, v1
    v_lshlrev_b32 v27, 2, v27
    v_add_u32 v27, s46, v27
    s_cmp_lt_u32 s67, 32
    s_cbranch_scc1 L_w1
    v_mov_b32 v27, -1
L_w1:
    s_cmp_eq_u32 s39, 0
    s_cbranch_scc1 L_w0
    v_mov_b32 v19, -1
    v_mov_b32 v27, -1
L_w0:
    s_add_u32 s56, s55, 1
    s_sub_u32 s57, s56, 10
    s_cmp_ge_u32 s56, 10
    s_cselect_b32 s56, s57, s56
    s_lshl_b32 s51, s56, 7
    s_mul_i32 s52, s56, 64*3072
    s_add_u32 m0, s48, 40960
    s_waitcnt vmcnt(9)
    buffer_load_dwordx4 v2, s[16:19], s51 offen offset:0 lds
    s_waitcnt vmcnt(9)
    buffer_load_dwordx4 v3, s[16:19], s51 offen offset:1024 lds
    s_waitcnt vmcnt(9)
    buffer_load_dwordx4 v4, s[16:19], s51 offen offset:2048 lds
    s_waitcnt vmcnt(9)
    buffer_load_dwordx4 v5, s[16:19], s51 offen offset:3072 lds
    s_add_u32 m0, s49, 40960
    s_waitcnt vmcnt(9)
    buffer_load_dwordx4 v6, s[20:23], s52 offen offset:0 lds
    s_waitcnt vmcnt(9)
    buffer_load_dwordx4 v7, s[20:23], s52 offen offset:1024 lds
    s_waitcnt vmcnt(9)
    buffer_load_dwordx4 v8, s[20:23], s52 offen offset:2048 lds
    s_add_u32 m0, s50, 40960
    s_waitcnt vmcnt(9)
    buffer_load_dwordx4 v6, s[24:27], s52 offen offset:0 lds
    s_waitcnt vmcnt(9)
    buffer_load_dwordx4 v7, s[24:27], s52 offen offset:1024 lds
    s_waitcnt vmcnt(9)
    buffer_load_dwordx4 v8, s[24:27], s52 offen offset:2048 lds
    s_waitcnt vmcnt(10)
    s_barrier
    s_add_u32 s56, s55, 2
    s_sub_u32 s57, s56, 10
    s_cmp_ge_u32 s56, 10
    s_cselect_b32 s56, s57, s56
    s_lshl_b32 s51, s56, 7
    s_mul_i32 s52, s56, 64*3072
    s_add_u32 m0, s48, 81920
    s_waitcnt vmcnt(9)
    buffer_load_dwordx4 v2, s[16:19], s51 offen offset:0 lds
    s_waitcnt vmcnt(9)
    buffer_load_dwordx4 v3, s[16:19], s51 offen offset:1024 lds
    s_waitcnt vmcnt(9)
    buffer_load_dwordx4 v4, s[16:19], s51 offen offset:2048 lds
    s_waitcnt vmcnt(9)
    buffer_load_dwordx4 v5, s[16:19], s51 offen offset:3072 lds
    s_add_u32 m0, s49, 81920
    s_waitcnt vmcnt(9)
    buffer_load_dwordx4 v6, s[20:23], s52 offen offset:0 lds
    s_waitcnt vmcnt(9)
    buffer_load_dwordx4 v7, s[20:23], s52 offen offset:1024 lds
    s_waitcnt vmcnt(9)
    buffer_load_dwordx4 v8, s[20:23], s52 offen offset:2048 lds
    s_add_u32 m0, s50, 81920
    s_waitcnt vmcnt(9)
    buffer_load_dwordx4 v6, s[24:27], s52 offen offset:0 lds
    s_waitcnt vmcnt(9)
    buffer_load_dwordx4 v7, s[24:27], s52 offen offset:1024 lds
    s_waitcnt vmcnt(9)
    buffer_load_dwordx4 v8, s[24:27], s52 offen offset:2048 lds
    s_waitcnt vmcnt(10)
    s_barrier
    s_add_u32 s56, s55, 3
    s_sub_u32 s57, s56, 10
    s_cmp_ge_u32 s56, 10
    s_cselect_b32 s56, s57, s56
    s_lshl_b32 s51, s56, 7
    s_mul_i32 s52, s56, 64*3072
    s_add_u32 m0, s48, 0
    s_waitcnt vmcnt(9)
    buffer_load_dwordx4 v2, s[16:19], s51 offen offset:0 lds
    s_waitcnt vmcnt(9)
    buffer_load_dwordx4 v3, s[16:19], s51 offen offset:1024 lds
    s_waitcnt vmcnt(9)
    buffer_load_dwordx4 v4, s[16:19], s51 offen offset:2048 lds
    s_waitcnt vmcnt(9)
    buffer_load_dwordx4 v5, s[16:19], s51 offen offset:3072 lds
    s_add_u32 m0, s49, 0
    s_waitcnt vmcnt(9)
    buffer_load_dwordx4 v6, s[20:23], s52 offen offset:0 lds
    s_waitcnt vmcnt(9)
    buffer_load_dwordx4 v7, s[20:23], s52 offen offset:1024 lds
    s_waitcnt vmcnt(9)
    buffer_load_dwordx4 v8, s[20:23], s52 offen offset:2048 lds
    s_add_u32 m0, s50, 0
    s_waitcnt vmcnt(9)
    buffer_load_dwordx4 v6, s[24:27], s52 offen offset:0 lds
    s_waitcnt vmcnt(9)
    buffer_load_dwordx4 v7, s[24:27], s52 offen offset:1024 lds
    s_waitcnt vmcnt(9)
    buffer_load_dwordx4 v8, s[24:27], s52 offen offset:2048 lds
    s_waitcnt vmcnt(10)
    s_barrier
    s_load_dword s65, s[14:15], 0
    s_add_u32 s56, s55, 4
    s_sub_u32 s57, s56, 10
    s_cmp_ge_u32 s56, 10
    s_cselect_b32 s56, s57, s56
    s_lshl_b32 s51, s56, 7
    s_mul_i32 s52, s56, 64*3072
    s_add_u32 m0, s48, 40960
    s_waitcnt vmcnt(9)
    buffer_load_dwordx4 v2, s[16:19], s51 offen offset:0 lds
    s_waitcnt vmcnt(9)
    buffer_load_dwordx4 v3, s[16:19], s51 offen offset:1024 lds
    s_waitcnt vmcnt(9)
    buffer_load_dwordx4 v4, s[16:19], s51 offen offset:2048 lds
    s_waitcnt vmcnt(9)
    buffer_load_dwordx4 v5, s[16:19], s51 offen offset:3072 lds
    s_add_u32 m0, s49, 40960
    s_waitcnt vmcnt(9)
    buffer_load_dwordx4 v6, s[20:23], s52 offen offset:0 lds
    s_waitcnt vmcnt(9)
    buffer_load_dwordx4 v7, s[20:23], s52 offen offset:1024 lds
    s_waitcnt vmcnt(9)
    buffer_load_dwordx4 v8, s[20:23], s52 offen offset:2048 lds
    s_add_u32 m0, s50, 40960
    s_waitcnt vmcnt(9)
    buffer_load_dwordx4 v6, s[24:27], s52 offen offset:0 lds
    s_waitcnt vmcnt(9)
    buffer_load_dwordx4 v7, s[24:27], s52 offen offset:1024 lds
    s_waitcnt vmcnt(9)
    buffer_load_dwordx4 v8, s[24:27], s52 offen offset:2048 lds
    s_waitcnt vmcnt(10)
    s_barrier
    s_add_u32 s56, s55, 5
    s_sub_u32 s57, s56, 10
    s_cmp_ge_u32 s56, 10
    s_cselect_b32 s56, s57, s56
    s_lshl_b32 s51, s56, 7
    s_mul_i32 s52, s56, 64*3072
    s_add_u32 m0, s48, 81920
    s_waitcnt vmcnt(9)
    buffer_load_dwordx4 v2, s[16:19], s51 offen offset:0 lds
    s_waitcnt vmcnt(9)
    buffer_load_dwordx4 v3, s[16:19], s51 offen offset:1024 lds
    s_waitcnt vmcnt(9)
    buffer_load_dwordx4 v4, s[16:19], s51 offen offset:2048 lds
    s_waitcnt vmcnt(9)
    buffer_load_dwordx4 v5, s[16:19], s51 offen offset:3072 lds
    s_add_u32 m0, s49, 81920
    s_waitcnt vmcnt(9)
    buffer_load_dwordx4 v6, s[20:23], s52 offen offset:0 lds
    s_waitcnt vmcnt(9)
    buffer_load_dwordx4 v7, s[20:23], s52 offen offset:1024 lds
    s_waitcnt vmcnt(9)
    buffer_load_dwordx4 v8, s[20:23], s52 offen offset:2048 lds
    s_add_u32 m0, s50, 81920
    s_waitcnt vmcnt(9)
    buffer_load_dwordx4 v6, s[24:27], s52 offen offset:0 lds
    s_waitcnt vmcnt(9)
    buffer_load_dwordx4 v7, s[24:27], s52 offen offset:1024 lds
    s_waitcnt vmcnt(9)
    buffer_load_dwordx4 v8, s[24:27], s52 offen offset:2048 lds
    s_waitcnt vmcnt(10)
    s_barrier
    s_add_u32 s56, s55, 6
    s_sub_u32 s57, s56, 10
    s_cmp_ge_u32 s56, 10
    s_cselect_b32 s56, s57, s56
    s_lshl_b32 s51, s56, 7
    s_mul_i32 s52, s56, 64*3072
    s_add_u32 m0, s48, 0
    s_waitcnt vmcnt(9)
    buffer_load_dwordx4 v2, s[16:19], s51 offen offset:0 lds
    s_waitcnt vmcnt(9)
    buffer_load_dwordx4 v3, s[16:19], s51 offen offset:1024 lds
    s_waitcnt vmcnt(9)
    buffer_load_dwordx4 v4, s[16:19], s51 offen offset:2048 lds
    s_waitcnt vmcnt(9)
    buffer_load_dwordx4 v5, s[16:19], s51 offen offset:3072 lds
    s_add_u32 m0, s49, 0
    s_waitcnt vmcnt(9)
    buffer_load_dwordx4 v6, s[20:23], s52 offen offset:0 lds
    s_waitcnt vmcnt(9)
    buffer_load_dwordx4 v7, s[20:23], s52 offen offset:1024 lds
    s_waitcnt vmcnt(9)
    buffer_load_dwordx4 v8, s[20:23], s52 offen offset:2048 lds
    s_add_u32 m0, s50, 0
    s_waitcnt vmcnt(9)
    buffer_load_dwordx4 v6, s[24:27], s52 offen offset:0 lds
    s_waitcnt vmcnt(9)
    buffer_load_dwordx4 v7, s[24:27], s52 offen offset:1024 lds
    s_waitcnt vmcnt(9)
    buffer_load_dwordx4 v8, s[24:27], s52 offen offset:2048 lds
    s_waitcnt vmcnt(10)
    s_barrier
    s_cmp_lg_u32 s39, 0
    s_cbranch_scc1 L_nowf
    s_waitcnt lgkmcnt(0)
    s_mov_b32 s66, 0
    s_cmp_lg_u32 s65, 0
    s_cbranch_scc1 L_wf
L_wfl:
    buffer_load_dword v25, v20, s[72:75], 0 offen sc1
    s_waitcnt vmcnt(0)
    v_readfirstlane_b32 s65, v25
    s_add_u32 s66, s66, 1
    s_cmp_gt_u32 s66, 1048576
    s_cbranch_scc1 L_wf
    s_cmp_eq_u32 s65, 0
    s_cbranch_scc1 L_wfl
L_wf:
    v_mov_b32 v25, s65
L_nowf:
    buffer_store_dword v25, v27, s[32:35], 0 offen sc1
    s_add_u32 s56, s55, 7
    s_sub_u32 s57, s56, 10
    s_cmp_ge_u32 s56, 10
    s_cselect_b32 s56, s57, s56
    s_lshl_b32 s51, s56, 7
    s_mul_i32 s52, s56, 64*3072
    s_add_u32 m0, s48, 40960
    s_waitcnt vmcnt(9)
    buffer_load_dwordx4 v2, s[16:19], s51 offen offset:0 lds
    s_waitcnt vmcnt(9)
    buffer_load_dwordx4 v3, s[16:19], s51 offen offset:1024 lds
    s_waitcnt vmcnt(9)
    buffer_load_dwordx4 v4, s[16:19], s51 offen offset:2048 lds
    s_waitcnt vmcnt(9)
    buffer_load_dwordx4 v5, s[16:19], s51 offen offset:3072 lds
    s_add_u32 m0, s49, 40960
    s_waitcnt vmcnt(9)
    buffer_load_dwordx4 v6, s[20:23], s52 offen offset:0 lds
    s_waitcnt vmcnt(9)
    buffer_load_dwordx4 v7, s[20:23], s52 offen offset:1024 lds
    s_waitcnt vmcnt(9)
    buffer_load_dwordx4 v8, s[20:23], s52 offen offset:2048 lds
    s_add_u32 m0, s50, 40960
    s_waitcnt vmcnt(9)
    buffer_load_dwordx4 v6, s[24:27], s52 offen offset:0 lds
    s_waitcnt vmcnt(9)
    buffer_load_dwordx4 v7, s[24:27], s52 offen offset:1024 lds
    s_waitcnt vmcnt(9)
    buffer_load_dwordx4 v8, s[24:27], s52 offen offset:2048 lds
    s_waitcnt vmcnt(11)
    s_barrier
    s_add_u32 s56, s55, 8
    s_sub_u32 s57, s56, 10
    s_cmp_ge_u32 s56, 10
    s_cselect_b32 s56, s57, s56
    s_lshl_b32 s51, s56, 7
    s_mul_i32 s52, s56, 64*3072
    s_add_u32 m0, s48, 81920
    s_waitcnt vmcnt(9)
    buffer_load_dwordx4 v2, s[16:19], s51 offen offset:0 lds
    s_waitcnt vmcnt(9)
    buffer_load_dwordx4 v3, s[16:19], s51 offen offset:1024 lds
    s_waitcnt vmcnt(9)
    buffer_load_dwordx4 v4, s[16:19], s51 offen offset:2048 lds
    s_waitcnt vmcnt(9)
    buffer_load_dwordx4 v5, s[16:19], s51 offen offset:3072 lds
    s_add_u32 m0, s49, 81920
    s_waitcnt vmcnt(9)
    buffer_load_dwordx4 v6, s[20:23], s52 offen offset:0 lds
    s_waitcnt vmcnt(9)
    buffer_load_dwordx4 v7, s[20:23], s52 offen offset:1024 lds
    s_waitcnt vmcnt(9)
    buffer_load_dwordx4 v8, s[20:23], s52 offen offset:2048 lds
    s_add_u32 m0, s50, 81920
    s_waitcnt vmcnt(9)
    buffer_load_dwordx4 v6, s[24:27], s52 offen offset:0 lds
    s_waitcnt vmcnt(9)
    buffer_load_dwordx4 v7, s[24:27], s52 offen offset:1024 lds
    s_waitcnt vmcnt(9)
    buffer_load_dwordx4 v8, s[24:27], s52 offen offset:2048 lds
    s_waitcnt vmcnt(10)
    buffer_load_dword v26, v19, s[32:35], 0 offen sc1
    s_barrier
    s_add_u32 s56, s55, 9
    s_sub_u32 s57, s56, 10
    s_cmp_ge_u32 s56, 10
    s_cselect_b32 s56, s57, s56
    s_lshl_b32 s51, s56, 7
    s_mul_i32 s52, s56, 64*3072
    s_add_u32 m0, s48, 0
    s_waitcnt vmcnt(9)
    buffer_load_dwordx4 v2, s[16:19], s51 offen offset:0 lds
    s_waitcnt vmcnt(9)
    buffer_load_dwordx4 v3, s[16:19], s51 offen offset:1024 lds
    s_waitcnt vmcnt(9)
    buffer_load_dwordx4 v4, s[16:19], s51 offen offset:2048 lds
    s_waitcnt vmcnt(9)
    buffer_load_dwordx4 v5, s[16:19], s51 offen offset:3072 lds
    s_add_u32 m0, s49, 0
    s_waitcnt vmcnt(9)
    buffer_load_dwordx4 v6, s[20:23], s52 offen offset:0 lds
    s_waitcnt vmcnt(9)
    buffer_load_dwordx4 v7, s[20:23], s52 offen offset:1024 lds
    s_waitcnt vmcnt(9)
    buffer_load_dwordx4 v8, s[20:23], s52 offen offset:2048 lds
    s_add_u32 m0, s50, 0
    s_waitcnt vmcnt(9)
    buffer_load_dwordx4 v6, s[24:27], s52 offen offset:0 lds
    s_waitcnt vmcnt(9)
    buffer_load_dwordx4 v7, s[24:27], s52 offen offset:1024 lds
    s_waitcnt vmcnt(9)
    buffer_load_dwordx4 v8, s[24:27], s52 offen offset:2048 lds
    s_waitcnt vmcnt(11)
    s_waitcnt vmcnt(10)
    s_cmp_lg_u32 s39, 0
    s_cbranch_scc1 L_wgo
    s_mov_b32 s66, 0
L_wchk:
    v_cmp_ne_u32 vcc, s65, v26
    s_add_u32 s66, s66, 1
    s_nop 0
    s_cmp_eq_u64 vcc, 0
    s_cbranch_scc1 L_wgo
    s_cmp_gt_u32 s66, 1048576
    s_cbranch_scc1 L_wgo
    s_sleep 2
    buffer_load_dword v26, v19, s[32:35], 0 offen sc1
    s_waitcnt vmcnt(0)
    s_branch L_wchk
L_wgo:
    s_barrier
    s_xor_b32 s58, s89, 0
    s_mul_i32 s58, s58, 20480
    s_add_u32 m0, s53, 122880
    s_waitcnt vmcnt(5)
    buffer_load_dwordx4 v16, s[32:35], s58 offen offset:0 sc1 lds
    s_waitcnt vmcnt(5)
    buffer_load_dwordx4 v16, s[32:35], s58 offen offset:1024 sc1 lds
    s_waitcnt vmcnt(5)
    buffer_load_dwordx4 v16, s[32:35], s58 offen offset:2048 sc1 lds
    s_waitcnt vmcnt(5)
    buffer_load_dwordx4 v16, s[32:35], s58 offen offset:3072 sc1 lds
    s_add_u32 m0, s53, 126976
    s_waitcnt vmcnt(5)
    buffer_load_dwordx4 v17, s[32:35], s58 offen offset:0 sc1 lds
    s_waitcnt vmcnt(5)
    buffer_load_dwordx4 v17, s[32:35], s58 offen offset:1024 sc1 lds
    s_waitcnt vmcnt(6)
    s_barrier
    s_add_u32 m0, s53, 126976
    s_waitcnt vmcnt(5)
    buffer_load_dwordx4 v17, s[32:35], s58 offen offset:2048 sc1 lds
    s_waitcnt vmcnt(5)
    buffer_load_dwordx4 v17, s[32:35], s58 offen offset:3072 sc1 lds
    s_add_u32 m0, s53, 131072
    s_waitcnt vmcnt(5)
    buffer_load_dwordx4 v18, s[32:35], s58 offen offset:0 sc1 lds
    s_waitcnt vmcnt(5)
    buffer_load_dwordx4 v18, s[32:35], s58 offen offset:1024 sc1 lds
    s_xor_b32 s58, s89, 1
    s_mul_i32 s58, s58, 20480
    s_add_u32 m0, s53, 40960
    s_waitcnt vmcnt(5)
    buffer_load_dwordx4 v16, s[32:35], s58 offen offset:0 sc1 lds
    s_barrier
    s_add_u32 m0, s53, 40960
    s_waitcnt vmcnt(5)
    buffer_load_dwordx4 v16, s[32:35], s58 offen offset:1024 sc1 lds
    s_waitcnt vmcnt(5)
    buffer_load_dwordx4 v16, s[32:35], s58 offen offset:2048 sc1 lds
    s_waitcnt vmcnt(5)
    buffer_load_dwordx4 v16, s[32:35], s58 offen offset:3072 sc1 lds
    s_add_u32 m0, s53, 45056
    s_waitcnt vmcnt(5)
    buffer_load_dwordx4 v17, s[32:35], s58 offen offset:0 sc1 lds
    s_waitcnt vmcnt(5)
    buffer_load_dwordx4 v17, s[32:35], s58 offen offset:1024 sc1 lds
    s_waitcnt vmcnt(5)
    buffer_load_dwordx4 v17, s[32:35], s58 offen offset:2048 sc1 lds
    s_waitcnt vmcnt(5)
    buffer_load_dwordx4 v17, s[32:35], s58 offen offset:3072 sc1 lds
    s_add_u32 m0, s53, 49152
    s_waitcnt vmcnt(5)
    buffer_load_dwordx4 v18, s[32:35], s58 offen offset:0 sc1 lds
    s_waitcnt vmcnt(5)
    buffer_load_dwordx4 v18, s[32:35], s58 offen offset:1024 sc1 lds
    s_xor_b32 s58, s89, 2
    s_mul_i32 s58, s58, 20480
    s_add_u32 m0, s53, 81920
    s_waitcnt vmcnt(5)
    buffer_load_dwordx4 v16, s[32:35], s58 offen offset:0 sc1 lds
    s_waitcnt vmcnt(5)
    buffer_load_dwordx4 v16, s[32:35], s58 offen offset:1024 sc1 lds
    s_waitcnt vmcnt(5)
    buffer_load_dwordx4 v16, s[32:35], s58 offen offset:2048 sc1 lds
    s_waitcnt vmcnt(5)
    buffer_load_dwordx4 v16, s[32:35], s58 offen offset:3072 sc1 lds
    s_add_u32 m0, s53, 86016
    s_waitcnt vmcnt(5)
    buffer_load_dwordx4 v17, s[32:35], s58 offen offset:0 sc1 lds
    s_waitcnt vmcnt(5)
    buffer_load_dwordx4 v17, s[32:35], s58 offen offset:1024 sc1 lds
    s_waitcnt vmcnt(5)
    buffer_load_dwordx4 v17, s[32:35], s58 offen offset:2048 sc1 lds
    s_waitcnt vmcnt(5)
    buffer_load_dwordx4 v17, s[32:35], s58 offen offset:3072 sc1 lds
    s_add_u32 m0, s53, 90112
    s_waitcnt vmcnt(5)
    buffer_load_dwordx4 v18, s[32:35], s58 offen offset:0 sc1 lds
    s_waitcnt vmcnt(5)
    buffer_load_dwordx4 v18, s[32:35], s58 offen offset:1024 sc1 lds
    s_xor_b32 s58, s89, 3
    s_mul_i32 s58, s58, 20480
    s_add_u32 m0, s53, 0
    s_waitcnt vmcnt(5)
    buffer_load_dwordx4 v16, s[32:35], s58 offen offset:0 sc1 lds
    s_waitcnt vmcnt(5)
    buffer_load_dwordx4 v16, s[32:35], s58 offen offset:1024 sc1 lds
    s_waitcnt vmcnt(5)
    buffer_load_dwordx4 v16, s[32:35], s58 offen offset:2048 sc1 lds
    s_waitcnt vmcnt(5)
    buffer_load_dwordx4 v16, s[32:35], s58 offen offset:3072 sc1 lds
    s_add_u32 m0, s53, 4096
    s_waitcnt vmcnt(5)
    buffer_load_dwordx4 v17, s[32:35], s58 offen offset:0 sc1 lds
    s_waitcnt vmcnt(5)
    buffer_load_dwordx4 v17, s[32:35], s58 offen offset:1024 sc1 lds
    s_waitcnt vmcnt(5)
    buffer_load_dwordx4 v17, s[32:35], s58 offen offset:2048 sc1 lds
    s_waitcnt vmcnt(5)
    buffer_load_dwordx4 v17, s[32:35], s58 offen offset:3072 sc1 lds
    s_add_u32 m0, s53, 8192
    s_waitcnt vmcnt(5)
    buffer_load_dwordx4 v18, s[32:35], s58 offen offset:0 sc1 lds
    s_waitcnt vmcnt(5)
    buffer_load_dwordx4 v18, s[32:35], s58 offen offset:1024 sc1 lds
    s_waitcnt vmcnt(20)
    s_barrier
    s_waitcnt vmcnt(0)
    s_barrier
    s_xor_b32 s58, s89, 4
    s_mul_i32 s58, s58, 20480
    s_add_u32 m0, s53, 122880
    s_waitcnt vmcnt(5)
    buffer_load_dwordx4 v16, s[32:35], s58 offen offset:0 sc1 lds
    s_waitcnt vmcnt(5)
    buffer_load_dwordx4 v16, s[32:35], s58 offen offset:1024 sc1 lds
    s_waitcnt vmcnt(5)
    buffer_load_dwordx4 v16, s[32:35], s58 offen offset:2048 sc1 lds
    s_waitcnt vmcnt(5)
    buffer_load_dwordx4 v16, s[32:35], s58 offen offset:3072 sc1 lds
    s_add_u32 m0, s53, 126976
    s_waitcnt vmcnt(5)
    buffer_load_dwordx4 v17, s[32:35], s58 offen offset:0 sc1 lds
    s_waitcnt vmcnt(5)
    buffer_load_dwordx4 v17, s[32:35], s58 offen offset:1024 sc1 lds
    s_waitcnt vmcnt(5)
    buffer_load_dwordx4 v17, s[32:35], s58 offen offset:2048 sc1 lds
    s_waitcnt vmcnt(5)
    buffer_load_dwordx4 v17, s[32:35], s58 offen offset:3072 sc1 lds
    s_add_u32 m0, s53, 131072
    s_waitcnt vmcnt(5)
    buffer_load_dwordx4 v18, s[32:35], s58 offen offset:0 sc1 lds
    s_waitcnt vmcnt(5)
    buffer_load_dwordx4 v18, s[32:35], s58 offen offset:1024 sc1 lds
    s_xor_b32 s58, s89, 5
    s_mul_i32 s58, s58, 20480
    s_add_u32 m0, s53, 40960
    s_waitcnt vmcnt(5)
    buffer_load_dwordx4 v16, s[32:35], s58 offen offset:0 sc1 lds
    s_waitcnt vmcnt(5)
    buffer_load_dwordx4 v16, s[32:35], s58 offen offset:1024 sc1 lds
    s_waitcnt vmcnt(5)
    buffer_load_dwordx4 v16, s[32:35], s58 offen offset:2048 sc1 lds
    s_waitcnt vmcnt(5)
    buffer_load_dwordx4 v16, s[32:35], s58 offen offset:3072 sc1 lds
    s_add_u32 m0, s53, 45056
    s_waitcnt vmcnt(5)
    buffer_load_dwordx4 v17, s[32:35], s58 offen offset:0 sc1 lds
    s_waitcnt vmcnt(5)
    buffer_load_dwordx4 v17, s[32:35], s58 offen offset:1024 sc1 lds
    s_waitcnt vmcnt(5)
    buffer_load_dwordx4 v17, s[32:35], s58 offen offset:2048 sc1 lds
    s_waitcnt vmcnt(5)
    buffer_load_dwordx4 v17, s[32:35], s58 offen offset:3072 sc1 lds
    s_add_u32 m0, s53, 49152
    s_waitcnt vmcnt(5)
    buffer_load_dwordx4 v18, s[32:35], s58 offen offset:0 sc1 lds
    s_waitcnt vmcnt(5)
    buffer_load_dwordx4 v18, s[32:35], s58 offen offset:1024 sc1 lds
    s_waitcnt vmcnt(0)
    s_barrier
L_end:
    s_endpgm
L_compute:
    s_lshl_b32 s62, s40, 2
    s_add_u32 s62, s62, s43
    s_mov_b32 s63, s42
    s_lshr_b32 s44, s64, 2
    s_lshl_b32 s45, s43, 1
    s_add_u32 s45, s45, s44
    s_lshl_b32 s46, s45, 1
    s_and_b32 s47, s64, 1
    s_add_u32 s46, s46, s47
    s_add_u32 s45, s45, 16
    s_bitcmp1_b32 s64, 1
    s_cselect_b32 s67, s45, s46
    s_and_b32 s47, s64, 3
    s_cmp_eq_u32 s47, 3
    s_cselect_b32 s67, 255, s67
    s_mov_b32 s89, 0
    s_mov_b32 s59, s40
    s_and_b32 s40, s38, 1
    s_lshr_b32 s41, s38, 1
    v_and_b32 v192, 15, v1
    s_lshl_b32 s42, s40, 6
    v_add_u32 v192, s42, v192
    v_lshlrev_b32 v192, 7, v192
    v_lshrrev_b32 v193, 4, v1
    v_bfe_u32 v194, v1, 1, 3
    v_xor_b32 v193, v193, v194
    v_xor_b32 v194, 0, v193
    v_lshlrev_b32 v194, 4, v194
    v_add_u32 v2, v192, v194
    v_add_u32 v4, 81920, v2
    v_xor_b32 v194, 4, v193
    v_lshlrev_b32 v194, 4, v194
    v_add_u32 v3, v192, v194
    v_add_u32 v5, 81920, v3
    v_bfe_u32 v192, v1, 4, 1
    v_lshrrev_b32 v193, 4, v1
    v_bfe_u32 v194, v1, 2, 2
    v_and_b32 v195, 3, v1
    v_lshlrev_b32 v193, 3, v193
    v_add_u32 v193, v193, v194
    v_mul_u32_u24 v193, 192, v193
    v_lshlrev_b32 v195, 3, v195
    v_add_u32 v193, v193, v195
    v_add_u32 v193, 16384, v193
    s_mul_i32 s42, s41, 3
    s_add_u32 s43, s42, 0
    v_xor_b32 v194, s43, v192
    v_lshlrev_b32 v194, 5, v194
    v_add_u32 v6, v193, v194
    v_add_u32 v9, 81920, v6
    s_add_u32 s43, s42, 1
    v_xor_b32 v194, s43, v192
    v_lshlrev_b32 v194, 5, v194
    v_add_u32 v7, v193, v194
    v_add_u32 v10, 81920, v7
    s_add_u32 s43, s42, 2
    v_xor_b32 v194, s43, v192
    v_lshlrev_b32 v194, 5, v194
    v_add_u32 v8, v193, v194
    v_add_u32 v11, 81920, v8
    v_lshrrev_b32 v192, 5, v1
    v_mul_u32_u24 v192, 49152, v192
    v_and_b32 v193, 31, v1
    v_lshlrev_b32 v193, 4, v193
    v_add_u32 v12, v192, v193
    s_lshl_b32 s44, s60, 3
    s_lshl_b32 s45, s40, 2
    s_add_u32 s44, s44, s45
    s_mul_i32 s44, s44, 49152
    s_lshr_b32 s45, s61, 3
    s_mul_i32 s45, s45, 24
    s_and_b32 s46, s61, 7
    s_add_u32 s45, s45, s46
    s_lshl_b32 s45, s45, 10
    s_add_u32 s44, s44, s45
    s_lshl_b32 s45, s41, 9
    s_add_u32 s44, s44, s45
    s_add_u32 s76, s44, 0
    s_add_u32 s77, s44, 98304
    s_add_u32 s78, s44, 8192
    s_add_u32 s79, s44, 106496
    s_add_u32 s80, s44, 16384
    s_add_u32 s81, s44, 114688
    v_mov_b32 v13, 0
    s_mov_b32 s82, 0xbfb8aa3b
    s_mov_b32 s83, 0xbfb8aa3b
    s_mov_b32 s84, 1.0
    s_mov_b32 s85, 1.0
    s_waitcnt lgkmcnt(0)
    s_mov_b32 s72, s14
    s_mov_b32 s73, s15
    s_mov_b32 s74, 256
    s_mov_b32 s75, 0x20000
    s_or_b32 s46, s2, s38
    s_cmp_lg_u32 s46, 0
    s_cbranch_scc1 L_nononce
    s_memrealtime s[46:47]
    s_waitcnt lgkmcnt(0)
    s_lshl_b32 s46, s46, 3
    s_or_b32 s46, s46, 4
    v_mov_b32 v14, s46
    buffer_store_dword v14, v13, s[72:75], 0 offen sc1
L_nononce:
    s_mov_b32 s32, s36
    s_mov_b32 s33, s37
    s_mov_b32 s34, 268435456
    s_mov_b32 s35, 0x20000
    s_mov_b32 s68, s12
    s_mov_b32 s69, s13
    s_mov_b32 s70, 2621440
    s_mov_b32 s71, 0x20000
    s_mov_b32 s28, s10
    s_mov_b32 s29, s11
    s_mov_b32 s30, 1966080
    s_mov_b32 s31, 0x20000
    s_lshl_b32 s46, s60, 1
    s_add_u32 s46, s46, s40
    s_lshl_b32 s46, s46, 5
    s_lshl_b32 s47, s61, 1
    s_add_u32 s46, s46, s47
    s_add_u32 s46, s46, s41
    s_lshl_b32 s46, s46, 9
    s_add_u32 s46, s46, 7340032
    v_and_b32 v208, 31, v1
    v_lshlrev_b32 v208, 2, v208
    v_add_u32 v208, s46, v208
    s_lshl_b32 s46, s62, 14
    s_lshl_b32 s47, s41, 13
    s_add_u32 s46, s46, s47
    s_add_u32 s46, s46, 7340032
    v_and_b32 v209, 15, v1
    v_lshlrev_b32 v209, 9, v209
    v_add_u32 v209, s46, v209
    v_lshlrev_b32 v214, 4, v1
    s_lshl_b32 s46, s62, 2
    s_lshl_b32 s47, s40, 1
    s_add_u32 s46, s46, s47
    s_mul_i32 s46, s46, 48
    s_mul_i32 s47, s41, 24
    s_add_u32 s46, s46, s47
    s_lshl_b32 s46, s46, 10
    s_mul_i32 s47, s41, 49152
    s_add_u32 s47, s47, s46
    v_add_u32 v211, s47, v214
    s_xor_b32 s47, s41, 1
    s_mul_i32 s47, s47, 49152
    s_add_u32 s47, s47, s46
    v_add_u32 v210, s47, v214
    v_lshrrev_b32 v192, 5, v1
    v_lshlrev_b32 v192, 4, v192
    v_bfe_u32 v193, v1, 4, 1
    v_lshlrev_b32 v193, 2, v193
    v_add_u32 v192, v192, v193
    v_bfe_u32 v193, v1, 2, 2
    v_add_u32 v192, v192, v193
    v_mul_u32_u24 v192, 160, v192
    v_and_b32 v193, 3, v1
    v_lshlrev_b32 v193, 3, v193
    v_add_u32 v192, v192, v193
    s_mul_i32 s46, s41, 20480
    v_add_u32 v212, s46, v192
    v_add_u32 v213, 81920, v212
    v_and_b32 v215, 15, v1
    s_lshl_b32 s46, s62, 6
    s_lshl_b32 s47, s40, 5
    s_add_u32 s46, s46, s47
    s_lshl_b32 s47, s41, 4
    s_add_u32 s46, s46, s47
    v_add_u32 v215, s46, v215
    v_mul_u32_u24 v215, 1280, v215
    v_lshrrev_b32 v192, 4, v1
    v_lshlrev_b32 v192, 3, v192
    v_add_u32 v215, v215, v192
    s_mul_i32 s46, s63, 160
    v_add_u32 v215, s46, v215
    s_mul_i32 s46, s67, 12
    s_mul_i32 s47, s38, 3
    s_add_u32 s46, s46, s47
    s_mul_i32 s47, s67, 6
    s_add_u32 s47, s47, 96
    s_lshl_b32 s48, s38, 1
    s_add_u32 s47, s47, s48
    s_cmp_lt_u32 s38, 3
    s_cselect_b32 s54, 2, 0
    s_cmp_lt_u32 s67, 16
    s_cselect_b32 s48, s46, s47
    s_cselect_b32 s54, 3, s54
    s_cmp_lt_u32 s67, 32
    s_cselect_b32 s54, s54, 0
    s_cselect_b32 s48, s48, 0
    s_lshl_b32 s46, s48, 6
    s_mul_i32 s49, s59, 160
    s_mov_b32 s50, 52429
    v_add_u32 v192, s46, v1
    v_mul_lo_u32 v193, v192, s50
    v_lshrrev_b32 v193, 19, v193
    v_mul_u32_u24 v194, 10, v193
    v_sub_u32 v194, v192, v194
    v_lshlrev_b32 v194, 4, v194
    v_lshrrev_b32 v195, 5, v193
    v_subrev_u32 v196, 24, v195
    v_cmp_gt_u32 vcc, 24, v195
    v_mov_b32 v197, 768
    s_nop 0
    v_cndmask_b32 v195, v196, v195, vcc
    v_cndmask_b32 v197, v197, v13, vcc
    v_and_b32 v196, 7, v195
    v_mul_u32_u24 v196, 96, v196
    v_add_u32 v197, v197, v196
    v_lshrrev_b32 v196, 3, v195
    v_lshlrev_b32 v196, 4, v196
    v_add_u32 v197, v197, v196
    v_bfe_u32 v196, v193, 4, 1
    v_mul_u32_u24 v196, 48, v196
    v_add_u32 v197, v197, v196
    v_and_b32 v196, 15, v193
    v_add_u32 v197, v197, v196
    v_mul_u32_u24 v197, 1280, v197
    v_add_u32 v249, v197, v194
    v_add_u32 v192, s46, v1
    v_add_u32 v192, 64, v192
    v_mul_lo_u32 v193, v192, s50
    v_lshrrev_b32 v193, 19, v193
    v_mul_u32_u24 v194, 10, v193
    v_sub_u32 v194, v192, v194
    v_lshlrev_b32 v194, 4, v194
    v_lshrrev_b32 v195, 5, v193
    v_subrev_u32 v196, 24, v195
    v_cmp_gt_u32 vcc, 24, v195
    v_mov_b32 v197, 768
    s_nop 0
    v_cndmask_b32 v195, v196, v195, vcc
    v_cndmask_b32 v197, v197, v13, vcc
    v_and_b32 v196, 7, v195
    v_mul_u32_u24 v196, 96, v196
    v_add_u32 v197, v197, v196
    v_lshrrev_b32 v196, 3, v195
    v_lshlrev_b32 v196, 4, v196
    v_add_u32 v197, v197, v196
    v_bfe_u32 v196, v193, 4, 1
    v_mul_u32_u24 v196, 48, v196
    v_add_u32 v197, v197, v196
    v_and_b32 v196, 15, v193
    v_add_u32 v197, v197, v196
    v_mul_u32_u24 v197, 1280, v197
    v_add_u32 v250, v197, v194
    v_add_u32 v192, s46, v1
    v_add_u32 v192, 128, v192
    v_mul_lo_u32 v193, v192, s50
    v_lshrrev_b32 v193, 19, v193
    v_mul_u32_u24 v194, 10, v193
    v_sub_u32 v194, v192, v194
    v_lshlrev_b32 v194, 4, v194
    v_lshrrev_b32 v195, 5, v193
    v_subrev_u32 v196, 24, v195
    v_cmp_gt_u32 vcc, 24, v195
    v_mov_b32 v197, 768
    s_nop 0
    v_cndmask_b32 v195, v196, v195, vcc
    v_cndmask_b32 v197, v197, v13, vcc
    v_and_b32 v196, 7, v195
    v_mul_u32_u24 v196, 96, v196
    v_add_u32 v197, v197, v196
    v_lshrrev_b32 v196, 3, v195
    v_lshlrev_b32 v196, 4, v196
    v_add_u32 v197, v197, v196
    v_bfe_u32 v196, v193, 4, 1
    v_mul_u32_u24 v196, 48, v196
    v_add_u32 v197, v197, v196
    v_and_b32 v196, 15, v193
    v_add_u32 v197, v197, v196
    v_mul_u32_u24 v197, 1280, v197
    v_add_u32 v251, v197, v194
    s_mul_i32 s50, s59, 240
    s_add_u32 s50, s50, s48
    s_lshl_b32 s50, s50, 10
    s_add_u32 s50, s50, 8388608
    s_barrier
    ds_read_b64_tr_b16 v[16:17], v6 offset:0
    ds_read_b64_tr_b16 v[18:19], v6 offset:768
    ds_read_b64_tr_b16 v[20:21], v6 offset:6144
    ds_read_b64_tr_b16 v[22:23], v6 offset:6912
    ds_read_b128 v[192:195], v2 offset:0
    ds_read_b128 v[216:219], v3 offset:0
    ds_read_b128 v[196:199], v2 offset:2048
    ds_read_b128 v[220:223], v3 offset:2048
    ds_read_b128 v[200:203], v2 offset:4096
    ds_read_b128 v[240:243], v3 offset:4096
    ds_read_b128 v[204:207], v2 offset:6144
    ds_read_b128 v[244:247], v3 offset:6144
    ds_read_b64_tr_b16 v[24:25], v6 offset:12288
    ds_read_b64_tr_b16 v[26:27], v6 offset:13056
    ds_read_b64_tr_b16 v[28:29], v6 offset:18432
    ds_read_b64_tr_b16 v[30:31], v6 offset:19200
    ds_read_b64_tr_b16 v[32:33], v7 offset:0
    ds_read_b64_tr_b16 v[34:35], v7 offset:768
    ds_read_b64_tr_b16 v[36:37], v7 offset:6144
    ds_read_b64_tr_b16 v[38:39], v7 offset:6912
    s_waitcnt lgkmcnt(8)
    v_mfma_f32_16x16x32_bf16 v[96:99], v[16:19], v[192:195], 0
    ds_read_b64_tr_b16 v[40:41], v7 offset:12288
    v_mfma_f32_16x16x32_bf16 v[96:99], v[20:23], v[216:219], v[96:99]
    ds_read_b64_tr_b16 v[42:43], v7 offset:13056
    v_mfma_f32_16x16x32_bf16 v[120:123], v[16:19], v[196:199], 0
    ds_read_b64_tr_b16 v[44:45], v7 offset:18432
    v_mfma_f32_16x16x32_bf16 v[120:123], v[20:23], v[220:223], v[120:123]
    ds_read_b64_tr_b16 v[46:47], v7 offset:19200
    v_mfma_f32_16x16x32_bf16 v[144:147], v[16:19], v[200:203], 0
    ds_read_b64_tr_b16 v[48:49], v8 offset:0
    v_mfma_f32_16x16x32_bf16 v[144:147], v[20:23], v[240:243], v[144:147]
    ds_read_b64_tr_b16 v[50:51], v8 offset:768
    v_mfma_f32_16x16x32_bf16 v[168:171], v[16:19], v[204:207], 0
    ds_read_b64_tr_b16 v[52:53], v8 offset:6144
    v_mfma_f32_16x16x32_bf16 v[168:171], v[20:23], v[244:247], v[168:171]
    ds_read_b64_tr_b16 v[54:55], v8 offset:6912
    s_waitcnt lgkmcnt(12)
    v_mfma_f32_16x16x32_bf16 v[100:103], v[24:27], v[192:195], 0
    ds_read_b64_tr_b16 v[56:57], v8 offset:12288
    v_mfma_f32_16x16x32_bf16 v[100:103], v[28:31], v[216:219], v[100:103]
    ds_read_b64_tr_b16 v[58:59], v8 offset:13056
    v_mfma_f32_16x16x32_bf16 v[124:127], v[24:27], v[196:199], 0
    ds_read_b64_tr_b16 v[60:61], v8 offset:18432
    v_mfma_f32_16x16x32_bf16 v[124:127], v[28:31], v[220:223], v[124:127]
    ds_read_b64_tr_b16 v[62:63], v8 offset:19200
    v_mfma_f32_16x16x32_bf16 v[148:151], v[24:27], v[200:203], 0
    v_mfma_f32_16x16x32_bf16 v[148:151], v[28:31], v[240:243], v[148:151]
    v_mfma_f32_16x16x32_bf16 v[172:175], v[24:27], v[204:207], 0
    v_mfma_f32_16x16x32_bf16 v[172:175], v[28:31], v[244:247], v[172:175]
    s_waitcnt lgkmcnt(12)
    v_mfma_f32_16x16x32_bf16 v[104:107], v[32:35], v[192:195], 0
    v_mfma_f32_16x16x32_bf16 v[104:107], v[36:39], v[216:219], v[104:107]
    v_mfma_f32_16x16x32_bf16 v[128:131], v[32:35], v[196:199], 0
    v_mfma_f32_16x16x32_bf16 v[128:131], v[36:39], v[220:223], v[128:131]
    v_mfma_f32_16x16x32_bf16 v[152:155], v[32:35], v[200:203], 0
    v_mfma_f32_16x16x32_bf16 v[152:155], v[36:39], v[240:243], v[152:155]
    v_mfma_f32_16x16x32_bf16 v[176:179], v[32:35], v[204:207], 0
    v_mfma_f32_16x16x32_bf16 v[176:179], v[36:39], v[244:247], v[176:179]
    s_waitcnt lgkmcnt(0)
    s_barrier
    v_mfma_f32_16x16x32_bf16 v[108:111], v[40:43], v[192:195], 0
    ds_read_b64_tr_b16 v[16:17], v6 offset:40960
    v_mfma_f32_16x16x32_bf16 v[108:111], v[44:47], v[216:219], v[108:111]
    ds_read_b64_tr_b16 v[18:19], v6 offset:41728
    v_mfma_f32_16x16x32_bf16 v[132:135], v[40:43], v[196:199], 0
    ds_read_b64_tr_b16 v[20:21], v6 offset:47104
    v_mfma_f32_16x16x32_bf16 v[132:135], v[44:47], v[220:223], v[132:135]
    ds_read_b64_tr_b16 v[22:23], v6 offset:47872
    v_mfma_f32_16x16x32_bf16 v[156:159], v[40:43], v[200:203], 0
    ds_read_b128 v[64:67], v2 offset:40960
    v_mfma_f32_16x16x32_bf16 v[156:159], v[44:47], v[240:243], v[156:159]
    ds_read_b128 v[80:83], v3 offset:40960
    v_mfma_f32_16x16x32_bf16 v[180:183], v[40:43], v[204:207], 0
    ds_read_b128 v[68:71], v2 offset:43008
    v_mfma_f32_16x16x32_bf16 v[180:183], v[44:47], v[244:247], v[180:183]
    ds_read_b128 v[84:87], v3 offset:43008
    v_mfma_f32_16x16x32_bf16 v[112:115], v[48:51], v[192:195], 0
    ds_read_b128 v[72:75], v2 offset:45056
    v_mfma_f32_16x16x32_bf16 v[112:115], v[52:55], v[216:219], v[112:115]
    ds_read_b128 v[88:91], v3 offset:45056
    v_mfma_f32_16x16x32_bf16 v[136:139], v[48:51], v[196:199], 0
    ds_read_b128 v[76:79], v2 offset:47104
    v_mfma_f32_16x16x32_bf16 v[136:139], v[52:55], v[220:223], v[136:139]
    ds_read_b128 v[92:95], v3 offset:47104
    v_mfma_f32_16x16x32_bf16 v[160:163], v[48:51], v[200:203], 0
    ds_read_b64_tr_b16 v[24:25], v6 offset:53248
    v_mfma_f32_16x16x32_bf16 v[160:163], v[52:55], v[240:243], v[160:163]
    ds_read_b64_tr_b16 v[26:27], v6 offset:54016
    v_mfma_f32_16x16x32_bf16 v[184:187], v[48:51], v[204:207], 0
    ds_read_b64_tr_b16 v[28:29], v6 offset:59392
    v_mfma_f32_16x16x32_bf16 v[184:187], v[52:55], v[244:247], v[184:187]
    ds_read_b64_tr_b16 v[30:31], v6 offset:60160
    v_mfma_f32_16x16x32_bf16 v[116:119], v[56:59], v[192:195], 0
    ds_read_b64_tr_b16 v[32:33], v7 offset:40960
    v_mfma_f32_16x16x32_bf16 v[116:119], v[60:63], v[216:219], v[116:119]
    ds_read_b64_tr_b16 v[34:35], v7 offset:41728
    v_mfma_f32_16x16x32_bf16 v[140:143], v[56:59], v[196:199], 0
    ds_read_b64_tr_b16 v[36:37], v7 offset:47104
    v_mfma_f32_16x16x32_bf16 v[140:143], v[60:63], v[220:223], v[140:143]
    ds_read_b64_tr_b16 v[38:39], v7 offset:47872
    v_mfma_f32_16x16x32_bf16 v[164:167], v[56:59], v[200:203], 0
    v_mfma_f32_16x16x32_bf16 v[164:167], v[60:63], v[240:243], v[164:167]
    v_mfma_f32_16x16x32_bf16 v[188:191], v[56:59], v[204:207], 0
    v_mfma_f32_16x16x32_bf16 v[188:191], v[60:63], v[244:247], v[188:191]
    s_waitcnt lgkmcnt(8)
    v_mfma_f32_16x16x32_bf16 v[96:99], v[16:19], v[64:67], v[96:99]
    ds_read_b64_tr_b16 v[40:41], v7 offset:53248
    v_mfma_f32_16x16x32_bf16 v[96:99], v[20:23], v[80:83], v[96:99]
    ds_read_b64_tr_b16 v[42:43], v7 offset:54016
    v_mfma_f32_16x16x32_bf16 v[120:123], v[16:19], v[68:71], v[120:123]
    ds_read_b64_tr_b16 v[44:45], v7 offset:59392
    v_mfma_f32_16x16x32_bf16 v[120:123], v[20:23], v[84:87], v[120:123]
    ds_read_b64_tr_b16 v[46:47], v7 offset:60160
    v_mfma_f32_16x16x32_bf16 v[144:147], v[16:19], v[72:75], v[144:147]
    ds_read_b64_tr_b16 v[48:49], v8 offset:40960
    v_mfma_f32_16x16x32_bf16 v[144:147], v[20:23], v[88:91], v[144:147]
    ds_read_b64_tr_b16 v[50:51], v8 offset:41728
    v_mfma_f32_16x16x32_bf16 v[168:171], v[16:19], v[76:79], v[168:171]
    ds_read_b64_tr_b16 v[52:53], v8 offset:47104
    v_mfma_f32_16x16x32_bf16 v[168:171], v[20:23], v[92:95], v[168:171]
    ds_read_b64_tr_b16 v[54:55], v8 offset:47872
    s_waitcnt lgkmcnt(12)
    v_mfma_f32_16x16x32_bf16 v[100:103], v[24:27], v[64:67], v[100:103]
    ds_read_b64_tr_b16 v[56:57], v8 offset:53248
    v_mfma_f32_16x16x32_bf16 v[100:103], v[28:31], v[80:83], v[100:103]
    ds_read_b64_tr_b16 v[58:59], v8 offset:54016
    v_mfma_f32_16x16x32_bf16 v[124:127], v[24:27], v[68:71], v[124:127]
    ds_read_b64_tr_b16 v[60:61], v8 offset:59392
    v_mfma_f32_16x16x32_bf16 v[124:127], v[28:31], v[84:87], v[124:127]
    ds_read_b64_tr_b16 v[62:63], v8 offset:60160
    v_mfma_f32_16x16x32_bf16 v[148:151], v[24:27], v[72:75], v[148:151]
    v_mfma_f32_16x16x32_bf16 v[148:151], v[28:31], v[88:91], v[148:151]
    v_mfma_f32_16x16x32_bf16 v[172:175], v[24:27], v[76:79], v[172:175]
    v_mfma_f32_16x16x32_bf16 v[172:175], v[28:31], v[92:95], v[172:175]
    s_waitcnt lgkmcnt(12)
    v_mfma_f32_16x16x32_bf16 v[104:107], v[32:35], v[64:67], v[104:107]
    v_mfma_f32_16x16x32_bf16 v[104:107], v[36:39], v[80:83], v[104:107]
    v_mfma_f32_16x16x32_bf16 v[128:131], v[32:35], v[68:71], v[128:131]
    v_mfma_f32_16x16x32_bf16 v[128:131], v[36:39], v[84:87], v[128:131]
    v_mfma_f32_16x16x32_bf16 v[152:155], v[32:35], v[72:75], v[152:155]
    v_mfma_f32_16x16x32_bf16 v[152:155], v[36:39], v[88:91], v[152:155]
    v_mfma_f32_16x16x32_bf16 v[176:179], v[32:35], v[76:79], v[176:179]
    v_mfma_f32_16x16x32_bf16 v[176:179], v[36:39], v[92:95], v[176:179]
    s_waitcnt lgkmcnt(0)
    s_barrier
    v_mfma_f32_16x16x32_bf16 v[108:111], v[40:43], v[64:67], v[108:111]
    ds_read_b64_tr_b16 v[16:17], v9 offset:0
    v_mfma_f32_16x16x32_bf16 v[108:111], v[44:47], v[80:83], v[108:111]
    ds_read_b64_tr_b16 v[18:19], v9 offset:768
    v_mfma_f32_16x16x32_bf16 v[132:135], v[40:43], v[68:71], v[132:135]
    ds_read_b64_tr_b16 v[20:21], v9 offset:6144
    v_mfma_f32_16x16x32_bf16 v[132:135], v[44:47], v[84:87], v[132:135]
    ds_read_b64_tr_b16 v[22:23], v9 offset:6912
    v_mfma_f32_16x16x32_bf16 v[156:159], v[40:43], v[72:75], v[156:159]
    ds_read_b128 v[192:195], v4 offset:0
    v_mfma_f32_16x16x32_bf16 v[156:159], v[44:47], v[88:91], v[156:159]
    ds_read_b128 v[216:219], v5 offset:0
    v_mfma_f32_16x16x32_bf16 v[180:183], v[40:43], v[76:79], v[180:183]
    ds_read_b128 v[196:199], v4 offset:2048
    v_mfma_f32_16x16x32_bf16 v[180:183], v[44:47], v[92:95], v[180:183]
    ds_read_b128 v[220:223], v5 offset:2048
    v_mfma_f32_16x16x32_bf16 v[112:115], v[48:51], v[64:67], v[112:115]
    ds_read_b128 v[200:203], v4 offset:4096
    v_mfma_f32_16x16x32_bf16 v[112:115], v[52:55], v[80:83], v[112:115]
    ds_read_b128 v[240:243], v5 offset:4096
    v_mfma_f32_16x16x32_bf16 v[136:139], v[48:51], v[68:71], v[136:139]
    ds_read_b128 v[204:207], v4 offset:6144
    v_mfma_f32_16x16x32_bf16 v[136:139], v[52:55], v[84:87], v[136:139]
    ds_read_b128 v[244:247], v5 offset:6144
    v_mfma_f32_16x16x32_bf16 v[160:163], v[48:51], v[72:75], v[160:163]
    ds_read_b64_tr_b16 v[24:25], v9 offset:12288
    v_mfma_f32_16x16x32_bf16 v[160:163], v[52:55], v[88:91], v[160:163]
    ds_read_b64_tr_b16 v[26:27], v9 offset:13056
    v_mfma_f32_16x16x32_bf16 v[184:187], v[48:51], v[76:79], v[184:187]
    ds_read_b64_tr_b16 v[28:29], v9 offset:18432
    v_mfma_f32_16x16x32_bf16 v[184:187], v[52:55], v[92:95], v[184:187]
    ds_read_b64_tr_b16 v[30:31], v9 offset:19200
    v_mfma_f32_16x16x32_bf16 v[116:119], v[56:59], v[64:67], v[116:119]
    ds_read_b64_tr_b16 v[32:33], v10 offset:0
    v_mfma_f32_16x16x32_bf16 v[116:119], v[60:63], v[80:83], v[116:119]
    ds_read_b64_tr_b16 v[34:35], v10 offset:768
    v_mfma_f32_16x16x32_bf16 v[140:143], v[56:59], v[68:71], v[140:143]
    ds_read_b64_tr_b16 v[36:37], v10 offset:6144
    v_mfma_f32_16x16x32_bf16 v[140:143], v[60:63], v[84:87], v[140:143]
    ds_read_b64_tr_b16 v[38:39], v10 offset:6912
    v_mfma_f32_16x16x32_bf16 v[164:167], v[56:59], v[72:75], v[164:167]
    v_mfma_f32_16x16x32_bf16 v[164:167], v[60:63], v[88:91], v[164:167]
    v_mfma_f32_16x16x32_bf16 v[188:191], v[56:59], v[76:79], v[188:191]
    v_mfma_f32_16x16x32_bf16 v[188:191], v[60:63], v[92:95], v[188:191]
    s_waitcnt lgkmcnt(8)
    v_mfma_f32_16x16x32_bf16 v[96:99], v[16:19], v[192:195], v[96:99]
    ds_read_b64_tr_b16 v[40:41], v10 offset:12288
    v_mfma_f32_16x16x32_bf16 v[96:99], v[20:23], v[216:219], v[96:99]
    ds_read_b64_tr_b16 v[42:43], v10 offset:13056
    v_mfma_f32_16x16x32_bf16 v[120:123], v[16:19], v[196:199], v[120:123]
    ds_read_b64_tr_b16 v[44:45], v10 offset:18432
    v_mfma_f32_16x16x32_bf16 v[120:123], v[20:23], v[220:223], v[120:123]
    ds_read_b64_tr_b16 v[46:47], v10 offset:19200
    v_mfma_f32_16x16x32_bf16 v[144:147], v[16:19], v[200:203], v[144:147]
    ds_read_b64_tr_b16 v[48:49], v11 offset:0
    v_mfma_f32_16x16x32_bf16 v[144:147], v[20:23], v[240:243], v[144:147]
    ds_read_b64_tr_b16 v[50:51], v11 offset:768
    v_mfma_f32_16x16x32_bf16 v[168:171], v[16:19], v[204:207], v[168:171]
    ds_read_b64_tr_b16 v[52:53], v11 offset:6144
    v_mfma_f32_16x16x32_bf16 v[168:171], v[20:23], v[244:247], v[168:171]
    ds_read_b64_tr_b16 v[54:55], v11 offset:6912
    s_waitcnt lgkmcnt(12)
    v_mfma_f32_16x16x32_bf16 v[100:103], v[24:27], v[192:195], v[100:103]
    ds_read_b64_tr_b16 v[56:57], v11 offset:12288
    v_mfma_f32_16x16x32_bf16 v[100:103], v[28:31], v[216:219], v[100:103]
    ds_read_b64_tr_b16 v[58:59], v11 offset:13056
    v_mfma_f32_16x16x32_bf16 v[124:127], v[24:27], v[196:199], v[124:127]
    ds_read_b64_tr_b16 v[60:61], v11 offset:18432
    v_mfma_f32_16x16x32_bf16 v[124:127], v[28:31], v[220:223], v[124:127]
    ds_read_b64_tr_b16 v[62:63], v11 offset:19200
    v_mfma_f32_16x16x32_bf16 v[148:151], v[24:27], v[200:203], v[148:151]
    v_mfma_f32_16x16x32_bf16 v[148:151], v[28:31], v[240:243], v[148:151]
    v_mfma_f32_16x16x32_bf16 v[172:175], v[24:27], v[204:207], v[172:175]
    v_mfma_f32_16x16x32_bf16 v[172:175], v[28:31], v[244:247], v[172:175]
    s_waitcnt lgkmcnt(12)
    v_mfma_f32_16x16x32_bf16 v[104:107], v[32:35], v[192:195], v[104:107]
    s_cmp_le_u32 s54, 0
    s_cbranch_scc1 L_nocp1
    buffer_load_dwordx4 v[224:227], v249, s[28:31], s49 offen
    s_cmp_le_u32 s54, 1
    s_cbranch_scc1 L_nocp1
    buffer_load_dwordx4 v[228:231], v250, s[28:31], s49 offen
    s_cmp_le_u32 s54, 2
    s_cbranch_scc1 L_nocp1
    buffer_load_dwordx4 v[232:235], v251, s[28:31], s49 offen
L_nocp1:
    v_mfma_f32_16x16x32_bf16 v[104:107], v[36:39], v[216:219], v[104:107]
    v_mfma_f32_16x16x32_bf16 v[128:131], v[32:35], v[196:199], v[128:131]
    v_mfma_f32_16x16x32_bf16 v[128:131], v[36:39], v[220:223], v[128:131]
    v_mfma_f32_16x16x32_bf16 v[152:155], v[32:35], v[200:203], v[152:155]
    v_mfma_f32_16x16x32_bf16 v[152:155], v[36:39], v[240:243], v[152:155]
    v_mfma_f32_16x16x32_bf16 v[176:179], v[32:35], v[204:207], v[176:179]
    v_mfma_f32_16x16x32_bf16 v[176:179], v[36:39], v[244:247], v[176:179]
    s_waitcnt lgkmcnt(0)
    s_barrier
    v_mfma_f32_16x16x32_bf16 v[108:111], v[40:43], v[192:195], v[108:111]
    ds_read_b64_tr_b16 v[16:17], v6 offset:0
    v_mfma_f32_16x16x32_bf16 v[108:111], v[44:47], v[216:219], v[108:111]
    ds_read_b64_tr_b16 v[18:19], v6 offset:768
    v_mfma_f32_16x16x32_bf16 v[132:135], v[40:43], v[196:199], v[132:135]
    ds_read_b64_tr_b16 v[20:21], v6 offset:6144
    v_mfma_f32_16x16x32_bf16 v[132:135], v[44:47], v[220:223], v[132:135]
    ds_read_b64_tr_b16 v[22:23], v6 offset:6912
    v_mfma_f32_16x16x32_bf16 v[156:159], v[40:43], v[200:203], v[156:159]
    ds_read_b128 v[64:67], v2 offset:0
    v_mfma_f32_16x16x32_bf16 v[156:159], v[44:47], v[240:243], v[156:159]
    ds_read_b128 v[80:83], v3 offset:0
    v_mfma_f32_16x16x32_bf16 v[180:183], v[40:43], v[204:207], v[180:183]
    ds_read_b128 v[68:71], v2 offset:2048
    v_mfma_f32_16x16x32_bf16 v[180:183], v[44:47], v[244:247], v[180:183]
    ds_read_b128 v[84:87], v3 offset:2048
    v_mfma_f32_16x16x32_bf16 v[112:115], v[48:51], v[192:195], v[112:115]
    ds_read_b128 v[72:75], v2 offset:4096
    v_mfma_f32_16x16x32_bf16 v[112:115], v[52:55], v[216:219], v[112:115]
    ds_read_b128 v[88:91], v3 offset:4096
    v_mfma_f32_16x16x32_bf16 v[136:139], v[48:51], v[196:199], v[136:139]
    ds_read_b128 v[76:79], v2 offset:6144
    v_mfma_f32_16x16x32_bf16 v[136:139], v[52:55], v[220:223], v[136:139]
    ds_read_b128 v[92:95], v3 offset:6144
    v_mfma_f32_16x16x32_bf16 v[160:163], v[48:51], v[200:203], v[160:163]
    ds_read_b64_tr_b16 v[24:25], v6 offset:12288
    v_mfma_f32_16x16x32_bf16 v[160:163], v[52:55], v[240:243], v[160:163]
    ds_read_b64_tr_b16 v[26:27], v6 offset:13056
    v_mfma_f32_16x16x32_bf16 v[184:187], v[48:51], v[204:207], v[184:187]
    ds_read_b64_tr_b16 v[28:29], v6 offset:18432
    v_mfma_f32_16x16x32_bf16 v[184:187], v[52:55], v[244:247], v[184:187]
    ds_read_b64_tr_b16 v[30:31], v6 offset:19200
    v_mfma_f32_16x16x32_bf16 v[116:119], v[56:59], v[192:195], v[116:119]
    ds_read_b64_tr_b16 v[32:33], v7 offset:0
    v_mfma_f32_16x16x32_bf16 v[116:119], v[60:63], v[216:219], v[116:119]
    ds_read_b64_tr_b16 v[34:35], v7 offset:768
    v_mfma_f32_16x16x32_bf16 v[140:143], v[56:59], v[196:199], v[140:143]
    ds_read_b64_tr_b16 v[36:37], v7 offset:6144
    v_mfma_f32_16x16x32_bf16 v[140:143], v[60:63], v[220:223], v[140:143]
    ds_read_b64_tr_b16 v[38:39], v7 offset:6912
    v_mfma_f32_16x16x32_bf16 v[164:167], v[56:59], v[200:203], v[164:167]
    v_mfma_f32_16x16x32_bf16 v[164:167], v[60:63], v[240:243], v[164:167]
    v_mfma_f32_16x16x32_bf16 v[188:191], v[56:59], v[204:207], v[188:191]
    v_mfma_f32_16x16x32_bf16 v[188:191], v[60:63], v[244:247], v[188:191]
    s_waitcnt lgkmcnt(8)
    v_mfma_f32_16x16x32_bf16 v[96:99], v[16:19], v[64:67], v[96:99]
    ds_read_b64_tr_b16 v[40:41], v7 offset:12288
    v_mfma_f32_16x16x32_bf16 v[96:99], v[20:23], v[80:83], v[96:99]
    ds_read_b64_tr_b16 v[42:43], v7 offset:13056
    v_mfma_f32_16x16x32_bf16 v[120:123], v[16:19], v[68:71], v[120:123]
    ds_read_b64_tr_b16 v[44:45], v7 offset:18432
    v_mfma_f32_16x16x32_bf16 v[120:123], v[20:23], v[84:87], v[120:123]
    ds_read_b64_tr_b16 v[46:47], v7 offset:19200
    v_mfma_f32_16x16x32_bf16 v[144:147], v[16:19], v[72:75], v[144:147]
    ds_read_b64_tr_b16 v[48:49], v8 offset:0
    v_mfma_f32_16x16x32_bf16 v[144:147], v[20:23], v[88:91], v[144:147]
    ds_read_b64_tr_b16 v[50:51], v8 offset:768
    v_mfma_f32_16x16x32_bf16 v[168:171], v[16:19], v[76:79], v[168:171]
    ds_read_b64_tr_b16 v[52:53], v8 offset:6144
    v_mfma_f32_16x16x32_bf16 v[168:171], v[20:23], v[92:95], v[168:171]
    ds_read_b64_tr_b16 v[54:55], v8 offset:6912
    s_waitcnt lgkmcnt(12)
    v_mfma_f32_16x16x32_bf16 v[100:103], v[24:27], v[64:67], v[100:103]
    ds_read_b64_tr_b16 v[56:57], v8 offset:12288
    v_mfma_f32_16x16x32_bf16 v[100:103], v[28:31], v[80:83], v[100:103]
    ds_read_b64_tr_b16 v[58:59], v8 offset:13056
    v_mfma_f32_16x16x32_bf16 v[124:127], v[24:27], v[68:71], v[124:127]
    ds_read_b64_tr_b16 v[60:61], v8 offset:18432
    v_mfma_f32_16x16x32_bf16 v[124:127], v[28:31], v[84:87], v[124:127]
    ds_read_b64_tr_b16 v[62:63], v8 offset:19200
    v_mfma_f32_16x16x32_bf16 v[148:151], v[24:27], v[72:75], v[148:151]
    v_mfma_f32_16x16x32_bf16 v[148:151], v[28:31], v[88:91], v[148:151]
    v_mfma_f32_16x16x32_bf16 v[172:175], v[24:27], v[76:79], v[172:175]
    v_mfma_f32_16x16x32_bf16 v[172:175], v[28:31], v[92:95], v[172:175]
    s_waitcnt lgkmcnt(12)
    v_mfma_f32_16x16x32_bf16 v[104:107], v[32:35], v[64:67], v[104:107]
    s_waitcnt vmcnt(0)
    s_cmp_le_u32 s54, 0
    s_cbranch_scc1 L_nocp2
    buffer_store_dwordx4 v[224:227], v214, s[32:35], s50 offen offset:0 sc1
    s_cmp_le_u32 s54, 1
    s_cbranch_scc1 L_nocp2
    buffer_store_dwordx4 v[228:231], v214, s[32:35], s50 offen offset:1024 sc1
    s_cmp_le_u32 s54, 2
    s_cbranch_scc1 L_nocp2
    buffer_store_dwordx4 v[232:235], v214, s[32:35], s50 offen offset:2048 sc1
L_nocp2:
    v_mfma_f32_16x16x32_bf16 v[104:107], v[36:39], v[80:83], v[104:107]
    v_mfma_f32_16x16x32_bf16 v[128:131], v[32:35], v[68:71], v[128:131]
    v_mfma_f32_16x16x32_bf16 v[128:131], v[36:39], v[84:87], v[128:131]
    v_mfma_f32_16x16x32_bf16 v[152:155], v[32:35], v[72:75], v[152:155]
    v_mfma_f32_16x16x32_bf16 v[152:155], v[36:39], v[88:91], v[152:155]
    v_mfma_f32_16x16x32_bf16 v[176:179], v[32:35], v[76:79], v[176:179]
    v_mfma_f32_16x16x32_bf16 v[176:179], v[36:39], v[92:95], v[176:179]
    s_waitcnt lgkmcnt(0)
    s_barrier
    v_mfma_f32_16x16x32_bf16 v[108:111], v[40:43], v[64:67], v[108:111]
    ds_read_b64_tr_b16 v[16:17], v6 offset:40960
    v_mfma_f32_16x16x32_bf16 v[108:111], v[44:47], v[80:83], v[108:111]
    ds_read_b64_tr_b16 v[18:19], v6 offset:41728
    v_mfma_f32_16x16x32_bf16 v[132:135], v[40:43], v[68:71], v[132:135]
    ds_read_b64_tr_b16 v[20:21], v6 offset:47104
    v_mfma_f32_16x16x32_bf16 v[132:135], v[44:47], v[84:87], v[132:135]
    ds_read_b64_tr_b16 v[22:23], v6 offset:47872
    v_mfma_f32_16x16x32_bf16 v[156:159], v[40:43], v[72:75], v[156:159]
    ds_read_b128 v[192:195], v2 offset:40960
    v_mfma_f32_16x16x32_bf16 v[156:159], v[44:47], v[88:91], v[156:159]
    ds_read_b128 v[216:219], v3 offset:40960
    v_mfma_f32_16x16x32_bf16 v[180:183], v[40:43], v[76:79], v[180:183]
    ds_read_b128 v[196:199], v2 offset:43008
    v_mfma_f32_16x16x32_bf16 v[180:183], v[44:47], v[92:95], v[180:183]
    ds_read_b128 v[220:223], v3 offset:43008
    v_mfma_f32_16x16x32_bf16 v[112:115], v[48:51], v[64:67], v[112:115]
    ds_read_b128 v[200:203], v2 offset:45056
    v_mfma_f32_16x16x32_bf16 v[112:115], v[52:55], v[80:83], v[112:115]
    ds_read_b128 v[240:243], v3 offset:45056
    v_mfma_f32_16x16x32_bf16 v[136:139], v[48:51], v[68:71], v[136:139]
    ds_read_b128 v[204:207], v2 offset:47104
    v_mfma_f32_16x16x32_bf16 v[136:139], v[52:55], v[84:87], v[136:139]
    ds_read_b128 v[244:247], v3 offset:47104
    v_mfma_f32_16x16x32_bf16 v[160:163], v[48:51], v[72:75], v[160:163]
    ds_read_b64_tr_b16 v[24:25], v6 offset:53248
    v_mfma_f32_16x16x32_bf16 v[160:163], v[52:55], v[88:91], v[160:163]
    ds_read_b64_tr_b16 v[26:27], v6 offset:54016
    v_mfma_f32_16x16x32_bf16 v[184:187], v[48:51], v[76:79], v[184:187]
    ds_read_b64_tr_b16 v[28:29], v6 offset:59392
    v_mfma_f32_16x16x32_bf16 v[184:187], v[52:55], v[92:95], v[184:187]
    ds_read_b64_tr_b16 v[30:31], v6 offset:60160
    v_mfma_f32_16x16x32_bf16 v[116:119], v[56:59], v[64:67], v[116:119]
    ds_read_b64_tr_b16 v[32:33], v7 offset:40960
    v_mfma_f32_16x16x32_bf16 v[116:119], v[60:63], v[80:83], v[116:119]
    ds_read_b64_tr_b16 v[34:35], v7 offset:41728
    v_mfma_f32_16x16x32_bf16 v[140:143], v[56:59], v[68:71], v[140:143]
    ds_read_b64_tr_b16 v[36:37], v7 offset:47104
    v_mfma_f32_16x16x32_bf16 v[140:143], v[60:63], v[84:87], v[140:143]
    ds_read_b64_tr_b16 v[38:39], v7 offset:47872
    v_mfma_f32_16x16x32_bf16 v[164:167], v[56:59], v[72:75], v[164:167]
    v_mfma_f32_16x16x32_bf16 v[164:167], v[60:63], v[88:91], v[164:167]
    v_mfma_f32_16x16x32_bf16 v[188:191], v[56:59], v[76:79], v[188:191]
    v_mfma_f32_16x16x32_bf16 v[188:191], v[60:63], v[92:95], v[188:191]
    s_waitcnt lgkmcnt(8)
    v_mfma_f32_16x16x32_bf16 v[96:99], v[16:19], v[192:195], v[96:99]
    ds_read_b64_tr_b16 v[40:41], v7 offset:53248
    v_mfma_f32_16x16x32_bf16 v[96:99], v[20:23], v[216:219], v[96:99]
    ds_read_b64_tr_b16 v[42:43], v7 offset:54016
    v_mfma_f32_16x16x32_bf16 v[120:123], v[16:19], v[196:199], v[120:123]
    ds_read_b64_tr_b16 v[44:45], v7 offset:59392
    v_mfma_f32_16x16x32_bf16 v[120:123], v[20:23], v[220:223], v[120:123]
    ds_read_b64_tr_b16 v[46:47], v7 offset:60160
    v_mfma_f32_16x16x32_bf16 v[144:147], v[16:19], v[200:203], v[144:147]
    ds_read_b64_tr_b16 v[48:49], v8 offset:40960
    v_mfma_f32_16x16x32_bf16 v[144:147], v[20:23], v[240:243], v[144:147]
    ds_read_b64_tr_b16 v[50:51], v8 offset:41728
    v_mfma_f32_16x16x32_bf16 v[168:171], v[16:19], v[204:207], v[168:171]
    ds_read_b64_tr_b16 v[52:53], v8 offset:47104
    v_mfma_f32_16x16x32_bf16 v[168:171], v[20:23], v[244:247], v[168:171]
    ds_read_b64_tr_b16 v[54:55], v8 offset:47872
    s_waitcnt lgkmcnt(12)
    v_mfma_f32_16x16x32_bf16 v[100:103], v[24:27], v[192:195], v[100:103]
    ds_read_b64_tr_b16 v[56:57], v8 offset:53248
    v_mfma_f32_16x16x32_bf16 v[100:103], v[28:31], v[216:219], v[100:103]
    ds_read_b64_tr_b16 v[58:59], v8 offset:54016
    v_mfma_f32_16x16x32_bf16 v[124:127], v[24:27], v[196:199], v[124:127]
    ds_read_b64_tr_b16 v[60:61], v8 offset:59392
    v_mfma_f32_16x16x32_bf16 v[124:127], v[28:31], v[220:223], v[124:127]
    ds_read_b64_tr_b16 v[62:63], v8 offset:60160
    v_mfma_f32_16x16x32_bf16 v[148:151], v[24:27], v[200:203], v[148:151]
    v_mfma_f32_16x16x32_bf16 v[148:151], v[28:31], v[240:243], v[148:151]
    v_mfma_f32_16x16x32_bf16 v[172:175], v[24:27], v[204:207], v[172:175]
    v_mfma_f32_16x16x32_bf16 v[172:175], v[28:31], v[244:247], v[172:175]
    s_waitcnt lgkmcnt(12)
    v_mfma_f32_16x16x32_bf16 v[104:107], v[32:35], v[192:195], v[104:107]
    v_mfma_f32_16x16x32_bf16 v[104:107], v[36:39], v[216:219], v[104:107]
    v_mfma_f32_16x16x32_bf16 v[128:131], v[32:35], v[196:199], v[128:131]
    v_mfma_f32_16x16x32_bf16 v[128:131], v[36:39], v[220:223], v[128:131]
    v_mfma_f32_16x16x32_bf16 v[152:155], v[32:35], v[200:203], v[152:155]
    v_mfma_f32_16x16x32_bf16 v[152:155], v[36:39], v[240:243], v[152:155]
    v_mfma_f32_16x16x32_bf16 v[176:179], v[32:35], v[204:207], v[176:179]
    v_mfma_f32_16x16x32_bf16 v[176:179], v[36:39], v[244:247], v[176:179]
    s_waitcnt vmcnt(0)
    s_waitcnt lgkmcnt(0)
    s_barrier
    v_mfma_f32_16x16x32_bf16 v[108:111], v[40:43], v[192:195], v[108:111]
    ds_read_b64_tr_b16 v[16:17], v9 offset:0
    v_mfma_f32_16x16x32_bf16 v[108:111], v[44:47], v[216:219], v[108:111]
    ds_read_b64_tr_b16 v[18:19], v9 offset:768
    v_mfma_f32_16x16x32_bf16 v[132:135], v[40:43], v[196:199], v[132:135]
    ds_read_b64_tr_b16 v[20:21], v9 offset:6144
    v_mfma_f32_16x16x32_bf16 v[132:135], v[44:47], v[220:223], v[132:135]
    ds_read_b64_tr_b16 v[22:23], v9 offset:6912
    v_mfma_f32_16x16x32_bf16 v[156:159], v[40:43], v[200:203], v[156:159]
    ds_read_b128 v[64:67], v4 offset:0
    v_mfma_f32_16x16x32_bf16 v[156:159], v[44:47], v[240:243], v[156:159]
    ds_read_b128 v[80:83], v5 offset:0
    v_mfma_f32_16x16x32_bf16 v[180:183], v[40:43], v[204:207], v[180:183]
    ds_read_b128 v[68:71], v4 offset:2048
    v_mfma_f32_16x16x32_bf16 v[180:183], v[44:47], v[244:247], v[180:183]
    ds_read_b128 v[84:87], v5 offset:2048
    v_mfma_f32_16x16x32_bf16 v[112:115], v[48:51], v[192:195], v[112:115]
    ds_read_b128 v[72:75], v4 offset:4096
    v_mfma_f32_16x16x32_bf16 v[112:115], v[52:55], v[216:219], v[112:115]
    ds_read_b128 v[88:91], v5 offset:4096
    v_mfma_f32_16x16x32_bf16 v[136:139], v[48:51], v[196:199], v[136:139]
    ds_read_b128 v[76:79], v4 offset:6144
    v_mfma_f32_16x16x32_bf16 v[136:139], v[52:55], v[220:223], v[136:139]
    ds_read_b128 v[92:95], v5 offset:6144
    v_mfma_f32_16x16x32_bf16 v[160:163], v[48:51], v[200:203], v[160:163]
    ds_read_b64_tr_b16 v[24:25], v9 offset:12288
    v_mfma_f32_16x16x32_bf16 v[160:163], v[52:55], v[240:243], v[160:163]
    ds_read_b64_tr_b16 v[26:27], v9 offset:13056
    v_mfma_f32_16x16x32_bf16 v[184:187], v[48:51], v[204:207], v[184:187]
    ds_read_b64_tr_b16 v[28:29], v9 offset:18432
    v_mfma_f32_16x16x32_bf16 v[184:187], v[52:55], v[244:247], v[184:187]
    ds_read_b64_tr_b16 v[30:31], v9 offset:19200
    v_mfma_f32_16x16x32_bf16 v[116:119], v[56:59], v[192:195], v[116:119]
    ds_read_b64_tr_b16 v[32:33], v10 offset:0
    v_mfma_f32_16x16x32_bf16 v[116:119], v[60:63], v[216:219], v[116:119]
    ds_read_b64_tr_b16 v[34:35], v10 offset:768
    v_mfma_f32_16x16x32_bf16 v[140:143], v[56:59], v[196:199], v[140:143]
    ds_read_b64_tr_b16 v[36:37], v10 offset:6144
    v_mfma_f32_16x16x32_bf16 v[140:143], v[60:63], v[220:223], v[140:143]
    ds_read_b64_tr_b16 v[38:39], v10 offset:6912
    v_mfma_f32_16x16x32_bf16 v[164:167], v[56:59], v[200:203], v[164:167]
    v_mfma_f32_16x16x32_bf16 v[164:167], v[60:63], v[240:243], v[164:167]
    v_mfma_f32_16x16x32_bf16 v[188:191], v[56:59], v[204:207], v[188:191]
    v_mfma_f32_16x16x32_bf16 v[188:191], v[60:63], v[244:247], v[188:191]
    s_waitcnt lgkmcnt(8)
    v_mfma_f32_16x16x32_bf16 v[96:99], v[16:19], v[64:67], v[96:99]
    ds_read_b64_tr_b16 v[40:41], v10 offset:12288
    v_mfma_f32_16x16x32_bf16 v[96:99], v[20:23], v[80:83], v[96:99]
    ds_read_b64_tr_b16 v[42:43], v10 offset:13056
    v_mfma_f32_16x16x32_bf16 v[120:123], v[16:19], v[68:71], v[120:123]
    ds_read_b64_tr_b16 v[44:45], v10 offset:18432
    v_mfma_f32_16x16x32_bf16 v[120:123], v[20:23], v[84:87], v[120:123]
    ds_read_b64_tr_b16 v[46:47], v10 offset:19200
    v_mfma_f32_16x16x32_bf16 v[144:147], v[16:19], v[72:75], v[144:147]
    ds_read_b64_tr_b16 v[48:49], v11 offset:0
    v_mfma_f32_16x16x32_bf16 v[144:147], v[20:23], v[88:91], v[144:147]
    ds_read_b64_tr_b16 v[50:51], v11 offset:768
    v_mfma_f32_16x16x32_bf16 v[168:171], v[16:19], v[76:79], v[168:171]
    ds_read_b64_tr_b16 v[52:53], v11 offset:6144
    v_mfma_f32_16x16x32_bf16 v[168:171], v[20:23], v[92:95], v[168:171]
    ds_read_b64_tr_b16 v[54:55], v11 offset:6912
    s_waitcnt lgkmcnt(12)
    v_mfma_f32_16x16x32_bf16 v[100:103], v[24:27], v[64:67], v[100:103]
    ds_read_b64_tr_b16 v[56:57], v11 offset:12288
    v_mfma_f32_16x16x32_bf16 v[100:103], v[28:31], v[80:83], v[100:103]
    ds_read_b64_tr_b16 v[58:59], v11 offset:13056
    v_mfma_f32_16x16x32_bf16 v[124:127], v[24:27], v[68:71], v[124:127]
    ds_read_b64_tr_b16 v[60:61], v11 offset:18432
    v_mfma_f32_16x16x32_bf16 v[124:127], v[28:31], v[84:87], v[124:127]
    ds_read_b64_tr_b16 v[62:63], v11 offset:19200
    v_mfma_f32_16x16x32_bf16 v[148:151], v[24:27], v[72:75], v[148:151]
    v_mfma_f32_16x16x32_bf16 v[148:151], v[28:31], v[88:91], v[148:151]
    v_mfma_f32_16x16x32_bf16 v[172:175], v[24:27], v[76:79], v[172:175]
    v_mfma_f32_16x16x32_bf16 v[172:175], v[28:31], v[92:95], v[172:175]
    s_waitcnt lgkmcnt(12)
    v_mfma_f32_16x16x32_bf16 v[104:107], v[32:35], v[64:67], v[104:107]
    v_mfma_f32_16x16x32_bf16 v[104:107], v[36:39], v[80:83], v[104:107]
    v_mfma_f32_16x16x32_bf16 v[128:131], v[32:35], v[68:71], v[128:131]
    v_mfma_f32_16x16x32_bf16 v[128:131], v[36:39], v[84:87], v[128:131]
    v_mfma_f32_16x16x32_bf16 v[152:155], v[32:35], v[72:75], v[152:155]
    v_mfma_f32_16x16x32_bf16 v[152:155], v[36:39], v[88:91], v[152:155]
    v_mfma_f32_16x16x32_bf16 v[176:179], v[32:35], v[76:79], v[176:179]
    v_mfma_f32_16x16x32_bf16 v[176:179], v[36:39], v[92:95], v[176:179]
    s_waitcnt lgkmcnt(0)
    s_barrier
    v_mfma_f32_16x16x32_bf16 v[108:111], v[40:43], v[64:67], v[108:111]
    ds_read_b64_tr_b16 v[16:17], v6 offset:0
    v_mfma_f32_16x16x32_bf16 v[108:111], v[44:47], v[80:83], v[108:111]
    ds_read_b64_tr_b16 v[18:19], v6 offset:768
    v_mfma_f32_16x16x32_bf16 v[132:135], v[40:43], v[68:71], v[132:135]
    ds_read_b64_tr_b16 v[20:21], v6 offset:6144
    v_mfma_f32_16x16x32_bf16 v[132:135], v[44:47], v[84:87], v[132:135]
    ds_read_b64_tr_b16 v[22:23], v6 offset:6912
    v_mfma_f32_16x16x32_bf16 v[156:159], v[40:43], v[72:75], v[156:159]
    ds_read_b128 v[192:195], v2 offset:0
    v_mfma_f32_16x16x32_bf16 v[156:159], v[44:47], v[88:91], v[156:159]
    ds_read_b128 v[216:219], v3 offset:0
    v_mfma_f32_16x16x32_bf16 v[180:183], v[40:43], v[76:79], v[180:183]
    ds_read_b128 v[196:199], v2 offset:2048
    v_mfma_f32_16x16x32_bf16 v[180:183], v[44:47], v[92:95], v[180:183]
    ds_read_b128 v[220:223], v3 offset:2048
    v_mfma_f32_16x16x32_bf16 v[112:115], v[48:51], v[64:67], v[112:115]
    ds_read_b128 v[200:203], v2 offset:4096
    v_mfma_f32_16x16x32_bf16 v[112:115], v[52:55], v[80:83], v[112:115]
    ds_read_b128 v[240:243], v3 offset:4096
    v_mfma_f32_16x16x32_bf16 v[136:139], v[48:51], v[68:71], v[136:139]
    ds_read_b128 v[204:207], v2 offset:6144
    v_mfma_f32_16x16x32_bf16 v[136:139], v[52:55], v[84:87], v[136:139]
    ds_read_b128 v[244:247], v3 offset:6144
    v_mfma_f32_16x16x32_bf16 v[160:163], v[48:51], v[72:75], v[160:163]
    ds_read_b64_tr_b16 v[24:25], v6 offset:12288
    v_mfma_f32_16x16x32_bf16 v[160:163], v[52:55], v[88:91], v[160:163]
    ds_read_b64_tr_b16 v[26:27], v6 offset:13056
    v_mfma_f32_16x16x32_bf16 v[184:187], v[48:51], v[76:79], v[184:187]
    ds_read_b64_tr_b16 v[28:29], v6 offset:18432
    v_mfma_f32_16x16x32_bf16 v[184:187], v[52:55], v[92:95], v[184:187]
    ds_read_b64_tr_b16 v[30:31], v6 offset:19200
    v_mfma_f32_16x16x32_bf16 v[116:119], v[56:59], v[64:67], v[116:119]
    ds_read_b64_tr_b16 v[32:33], v7 offset:0
    v_mfma_f32_16x16x32_bf16 v[116:119], v[60:63], v[80:83], v[116:119]
    ds_read_b64_tr_b16 v[34:35], v7 offset:768
    v_mfma_f32_16x16x32_bf16 v[140:143], v[56:59], v[68:71], v[140:143]
    ds_read_b64_tr_b16 v[36:37], v7 offset:6144
    v_mfma_f32_16x16x32_bf16 v[140:143], v[60:63], v[84:87], v[140:143]
    ds_read_b64_tr_b16 v[38:39], v7 offset:6912
    v_mfma_f32_16x16x32_bf16 v[164:167], v[56:59], v[72:75], v[164:167]
    v_mfma_f32_16x16x32_bf16 v[164:167], v[60:63], v[88:91], v[164:167]
    v_mfma_f32_16x16x32_bf16 v[188:191], v[56:59], v[76:79], v[188:191]
    v_mfma_f32_16x16x32_bf16 v[188:191], v[60:63], v[92:95], v[188:191]
    s_waitcnt lgkmcnt(8)
    v_mfma_f32_16x16x32_bf16 v[96:99], v[16:19], v[192:195], v[96:99]
    ds_read_b64_tr_b16 v[40:41], v7 offset:12288
    v_mfma_f32_16x16x32_bf16 v[96:99], v[20:23], v[216:219], v[96:99]
    ds_read_b64_tr_b16 v[42:43], v7 offset:13056
    v_mfma_f32_16x16x32_bf16 v[120:123], v[16:19], v[196:199], v[120:123]
    ds_read_b64_tr_b16 v[44:45], v7 offset:18432
    v_mfma_f32_16x16x32_bf16 v[120:123], v[20:23], v[220:223], v[120:123]
    ds_read_b64_tr_b16 v[46:47], v7 offset:19200
    v_mfma_f32_16x16x32_bf16 v[144:147], v[16:19], v[200:203], v[144:147]
    ds_read_b64_tr_b16 v[48:49], v8 offset:0
    v_mfma_f32_16x16x32_bf16 v[144:147], v[20:23], v[240:243], v[144:147]
    ds_read_b64_tr_b16 v[50:51], v8 offset:768
    v_mfma_f32_16x16x32_bf16 v[168:171], v[16:19], v[204:207], v[168:171]
    ds_read_b64_tr_b16 v[52:53], v8 offset:6144
    v_mfma_f32_16x16x32_bf16 v[168:171], v[20:23], v[244:247], v[168:171]
    ds_read_b64_tr_b16 v[54:55], v8 offset:6912
    s_waitcnt lgkmcnt(12)
    v_mfma_f32_16x16x32_bf16 v[100:103], v[24:27], v[192:195], v[100:103]
    ds_read_b64_tr_b16 v[56:57], v8 offset:12288
    v_mfma_f32_16x16x32_bf16 v[100:103], v[28:31], v[216:219], v[100:103]
    ds_read_b64_tr_b16 v[58:59], v8 offset:13056
    v_mfma_f32_16x16x32_bf16 v[124:127], v[24:27], v[196:199], v[124:127]
    ds_read_b64_tr_b16 v[60:61], v8 offset:18432
    v_mfma_f32_16x16x32_bf16 v[124:127], v[28:31], v[220:223], v[124:127]
    ds_read_b64_tr_b16 v[62:63], v8 offset:19200
    v_mfma_f32_16x16x32_bf16 v[148:151], v[24:27], v[200:203], v[148:151]
    v_mfma_f32_16x16x32_bf16 v[148:151], v[28:31], v[240:243], v[148:151]
    v_mfma_f32_16x16x32_bf16 v[172:175], v[24:27], v[204:207], v[172:175]
    v_mfma_f32_16x16x32_bf16 v[172:175], v[28:31], v[244:247], v[172:175]
    s_waitcnt lgkmcnt(12)
    v_mfma_f32_16x16x32_bf16 v[104:107], v[32:35], v[192:195], v[104:107]
    v_mfma_f32_16x16x32_bf16 v[104:107], v[36:39], v[216:219], v[104:107]
    v_mfma_f32_16x16x32_bf16 v[128:131], v[32:35], v[196:199], v[128:131]
    v_mfma_f32_16x16x32_bf16 v[128:131], v[36:39], v[220:223], v[128:131]
    v_mfma_f32_16x16x32_bf16 v[152:155], v[32:35], v[200:203], v[152:155]
    v_mfma_f32_16x16x32_bf16 v[152:155], v[36:39], v[240:243], v[152:155]
    v_mfma_f32_16x16x32_bf16 v[176:179], v[32:35], v[204:207], v[176:179]
    v_mfma_f32_16x16x32_bf16 v[176:179], v[36:39], v[244:247], v[176:179]
    s_waitcnt lgkmcnt(0)
    s_barrier
    v_mfma_f32_16x16x32_bf16 v[108:111], v[40:43], v[192:195], v[108:111]
    ds_read_b64_tr_b16 v[16:17], v6 offset:40960
    v_mfma_f32_16x16x32_bf16 v[108:111], v[44:47], v[216:219], v[108:111]
    ds_read_b64_tr_b16 v[18:19], v6 offset:41728
    v_mfma_f32_16x16x32_bf16 v[132:135], v[40:43], v[196:199], v[132:135]
    ds_read_b64_tr_b16 v[20:21], v6 offset:47104
    v_mfma_f32_16x16x32_bf16 v[132:135], v[44:47], v[220:223], v[132:135]
    ds_read_b64_tr_b16 v[22:23], v6 offset:47872
    v_mfma_f32_16x16x32_bf16 v[156:159], v[40:43], v[200:203], v[156:159]
    ds_read_b128 v[64:67], v2 offset:40960
    v_mfma_f32_16x16x32_bf16 v[156:159], v[44:47], v[240:243], v[156:159]
    ds_read_b128 v[80:83], v3 offset:40960
    v_mfma_f32_16x16x32_bf16 v[180:183], v[40:43], v[204:207], v[180:183]
    ds_read_b128 v[68:71], v2 offset:43008
    v_mfma_f32_16x16x32_bf16 v[180:183], v[44:47], v[244:247], v[180:183]
    ds_read_b128 v[84:87], v3 offset:43008
    v_mfma_f32_16x16x32_bf16 v[112:115], v[48:51], v[192:195], v[112:115]
    ds_read_b128 v[72:75], v2 offset:45056
    v_mfma_f32_16x16x32_bf16 v[112:115], v[52:55], v[216:219], v[112:115]
    ds_read_b128 v[88:91], v3 offset:45056
    v_mfma_f32_16x16x32_bf16 v[136:139], v[48:51], v[196:199], v[136:139]
    ds_read_b128 v[76:79], v2 offset:47104
    v_mfma_f32_16x16x32_bf16 v[136:139], v[52:55], v[220:223], v[136:139]
    ds_read_b128 v[92:95], v3 offset:47104
    v_mfma_f32_16x16x32_bf16 v[160:163], v[48:51], v[200:203], v[160:163]
    ds_read_b64_tr_b16 v[24:25], v6 offset:53248
    v_mfma_f32_16x16x32_bf16 v[160:163], v[52:55], v[240:243], v[160:163]
    ds_read_b64_tr_b16 v[26:27], v6 offset:54016
    v_mfma_f32_16x16x32_bf16 v[184:187], v[48:51], v[204:207], v[184:187]
    ds_read_b64_tr_b16 v[28:29], v6 offset:59392
    v_mfma_f32_16x16x32_bf16 v[184:187], v[52:55], v[244:247], v[184:187]
    ds_read_b64_tr_b16 v[30:31], v6 offset:60160
    v_mfma_f32_16x16x32_bf16 v[116:119], v[56:59], v[192:195], v[116:119]
    ds_read_b64_tr_b16 v[32:33], v7 offset:40960
    v_mfma_f32_16x16x32_bf16 v[116:119], v[60:63], v[216:219], v[116:119]
    ds_read_b64_tr_b16 v[34:35], v7 offset:41728
    v_mfma_f32_16x16x32_bf16 v[140:143], v[56:59], v[196:199], v[140:143]
    ds_read_b64_tr_b16 v[36:37], v7 offset:47104
    v_mfma_f32_16x16x32_bf16 v[140:143], v[60:63], v[220:223], v[140:143]
    ds_read_b64_tr_b16 v[38:39], v7 offset:47872
    v_mfma_f32_16x16x32_bf16 v[164:167], v[56:59], v[200:203], v[164:167]
    v_mfma_f32_16x16x32_bf16 v[164:167], v[60:63], v[240:243], v[164:167]
    v_mfma_f32_16x16x32_bf16 v[188:191], v[56:59], v[204:207], v[188:191]
    v_mfma_f32_16x16x32_bf16 v[188:191], v[60:63], v[244:247], v[188:191]
    s_waitcnt lgkmcnt(8)
    v_mfma_f32_16x16x32_bf16 v[96:99], v[16:19], v[64:67], v[96:99]
    ds_read_b64_tr_b16 v[40:41], v7 offset:53248
    v_mfma_f32_16x16x32_bf16 v[96:99], v[20:23], v[80:83], v[96:99]
    ds_read_b64_tr_b16 v[42:43], v7 offset:54016
    v_mfma_f32_16x16x32_bf16 v[120:123], v[16:19], v[68:71], v[120:123]
    ds_read_b64_tr_b16 v[44:45], v7 offset:59392
    v_mfma_f32_16x16x32_bf16 v[120:123], v[20:23], v[84:87], v[120:123]
    ds_read_b64_tr_b16 v[46:47], v7 offset:60160
    v_mfma_f32_16x16x32_bf16 v[144:147], v[16:19], v[72:75], v[144:147]
    ds_read_b64_tr_b16 v[48:49], v8 offset:40960
    v_mfma_f32_16x16x32_bf16 v[144:147], v[20:23], v[88:91], v[144:147]
    ds_read_b64_tr_b16 v[50:51], v8 offset:41728
    v_mfma_f32_16x16x32_bf16 v[168:171], v[16:19], v[76:79], v[168:171]
    ds_read_b64_tr_b16 v[52:53], v8 offset:47104
    v_mfma_f32_16x16x32_bf16 v[168:171], v[20:23], v[92:95], v[168:171]
    ds_read_b64_tr_b16 v[54:55], v8 offset:47872
    s_waitcnt lgkmcnt(12)
    v_mfma_f32_16x16x32_bf16 v[100:103], v[24:27], v[64:67], v[100:103]
    ds_read_b64_tr_b16 v[56:57], v8 offset:53248
    v_mfma_f32_16x16x32_bf16 v[100:103], v[28:31], v[80:83], v[100:103]
    ds_read_b64_tr_b16 v[58:59], v8 offset:54016
    v_mfma_f32_16x16x32_bf16 v[124:127], v[24:27], v[68:71], v[124:127]
    ds_read_b64_tr_b16 v[60:61], v8 offset:59392
    v_mfma_f32_16x16x32_bf16 v[124:127], v[28:31], v[84:87], v[124:127]
    ds_read_b64_tr_b16 v[62:63], v8 offset:60160
    v_mfma_f32_16x16x32_bf16 v[148:151], v[24:27], v[72:75], v[148:151]
    v_mfma_f32_16x16x32_bf16 v[148:151], v[28:31], v[88:91], v[148:151]
    v_mfma_f32_16x16x32_bf16 v[172:175], v[24:27], v[76:79], v[172:175]
    v_mfma_f32_16x16x32_bf16 v[172:175], v[28:31], v[92:95], v[172:175]
    s_waitcnt lgkmcnt(12)
    v_mfma_f32_16x16x32_bf16 v[104:107], v[32:35], v[64:67], v[104:107]
    v_mfma_f32_16x16x32_bf16 v[104:107], v[36:39], v[80:83], v[104:107]
    v_mfma_f32_16x16x32_bf16 v[128:131], v[32:35], v[68:71], v[128:131]
    v_mfma_f32_16x16x32_bf16 v[128:131], v[36:39], v[84:87], v[128:131]
    v_mfma_f32_16x16x32_bf16 v[152:155], v[32:35], v[72:75], v[152:155]
    v_mfma_f32_16x16x32_bf16 v[152:155], v[36:39], v[88:91], v[152:155]
    v_mfma_f32_16x16x32_bf16 v[176:179], v[32:35], v[76:79], v[176:179]
    v_mfma_f32_16x16x32_bf16 v[176:179], v[36:39], v[92:95], v[176:179]
    s_waitcnt lgkmcnt(0)
    s_barrier
    v_mfma_f32_16x16x32_bf16 v[108:111], v[40:43], v[64:67], v[108:111]
    ds_read_b64_tr_b16 v[16:17], v9 offset:0
    v_mfma_f32_16x16x32_bf16 v[108:111], v[44:47], v[80:83], v[108:111]
    ds_read_b64_tr_b16 v[18:19], v9 offset:768
    v_mfma_f32_16x16x32_bf16 v[132:135], v[40:43], v[68:71], v[132:135]
    ds_read_b64_tr_b16 v[20:21], v9 offset:6144
    v_mfma_f32_16x16x32_bf16 v[132:135], v[44:47], v[84:87], v[132:135]
    ds_read_b64_tr_b16 v[22:23], v9 offset:6912
    v_mfma_f32_16x16x32_bf16 v[156:159], v[40:43], v[72:75], v[156:159]
    ds_read_b128 v[192:195], v4 offset:0
    v_mfma_f32_16x16x32_bf16 v[156:159], v[44:47], v[88:91], v[156:159]
    ds_read_b128 v[216:219], v5 offset:0
    v_mfma_f32_16x16x32_bf16 v[180:183], v[40:43], v[76:79], v[180:183]
    ds_read_b128 v[196:199], v4 offset:2048
    v_mfma_f32_16x16x32_bf16 v[180:183], v[44:47], v[92:95], v[180:183]
    ds_read_b128 v[220:223], v5 offset:2048
    v_mfma_f32_16x16x32_bf16 v[112:115], v[48:51], v[64:67], v[112:115]
    ds_read_b128 v[200:203], v4 offset:4096
    v_mfma_f32_16x16x32_bf16 v[112:115], v[52:55], v[80:83], v[112:115]
    ds_read_b128 v[240:243], v5 offset:4096
    v_mfma_f32_16x16x32_bf16 v[136:139], v[48:51], v[68:71], v[136:139]
    ds_read_b128 v[204:207], v4 offset:6144
    v_mfma_f32_16x16x32_bf16 v[136:139], v[52:55], v[84:87], v[136:139]
    ds_read_b128 v[244:247], v5 offset:6144
    v_mfma_f32_16x16x32_bf16 v[160:163], v[48:51], v[72:75], v[160:163]
    ds_read_b64_tr_b16 v[24:25], v9 offset:12288
    v_mfma_f32_16x16x32_bf16 v[160:163], v[52:55], v[88:91], v[160:163]
    ds_read_b64_tr_b16 v[26:27], v9 offset:13056
    v_mfma_f32_16x16x32_bf16 v[184:187], v[48:51], v[76:79], v[184:187]
    ds_read_b64_tr_b16 v[28:29], v9 offset:18432
    v_mfma_f32_16x16x32_bf16 v[184:187], v[52:55], v[92:95], v[184:187]
    ds_read_b64_tr_b16 v[30:31], v9 offset:19200
    v_mfma_f32_16x16x32_bf16 v[116:119], v[56:59], v[64:67], v[116:119]
    ds_read_b64_tr_b16 v[32:33], v10 offset:0
    v_mfma_f32_16x16x32_bf16 v[116:119], v[60:63], v[80:83], v[116:119]
    ds_read_b64_tr_b16 v[34:35], v10 offset:768
    v_mfma_f32_16x16x32_bf16 v[140:143], v[56:59], v[68:71], v[140:143]
    ds_read_b64_tr_b16 v[36:37], v10 offset:6144
    v_mfma_f32_16x16x32_bf16 v[140:143], v[60:63], v[84:87], v[140:143]
    ds_read_b64_tr_b16 v[38:39], v10 offset:6912
    v_mfma_f32_16x16x32_bf16 v[164:167], v[56:59], v[72:75], v[164:167]
    v_mfma_f32_16x16x32_bf16 v[164:167], v[60:63], v[88:91], v[164:167]
    v_mfma_f32_16x16x32_bf16 v[188:191], v[56:59], v[76:79], v[188:191]
    v_mfma_f32_16x16x32_bf16 v[188:191], v[60:63], v[92:95], v[188:191]
    s_waitcnt lgkmcnt(8)
    v_mfma_f32_16x16x32_bf16 v[96:99], v[16:19], v[192:195], v[96:99]
    ds_read_b64_tr_b16 v[40:41], v10 offset:12288
    v_mfma_f32_16x16x32_bf16 v[96:99], v[20:23], v[216:219], v[96:99]
    ds_read_b64_tr_b16 v[42:43], v10 offset:13056
    v_mfma_f32_16x16x32_bf16 v[120:123], v[16:19], v[196:199], v[120:123]
    ds_read_b64_tr_b16 v[44:45], v10 offset:18432
    v_mfma_f32_16x16x32_bf16 v[120:123], v[20:23], v[220:223], v[120:123]
    ds_read_b64_tr_b16 v[46:47], v10 offset:19200
    v_mfma_f32_16x16x32_bf16 v[144:147], v[16:19], v[200:203], v[144:147]
    ds_read_b64_tr_b16 v[48:49], v11 offset:0
    v_mfma_f32_16x16x32_bf16 v[144:147], v[20:23], v[240:243], v[144:147]
    ds_read_b64_tr_b16 v[50:51], v11 offset:768
    v_mfma_f32_16x16x32_bf16 v[168:171], v[16:19], v[204:207], v[168:171]
    ds_read_b64_tr_b16 v[52:53], v11 offset:6144
    v_mfma_f32_16x16x32_bf16 v[168:171], v[20:23], v[244:247], v[168:171]
    ds_read_b64_tr_b16 v[54:55], v11 offset:6912
    s_waitcnt lgkmcnt(12)
    v_mfma_f32_16x16x32_bf16 v[100:103], v[24:27], v[192:195], v[100:103]
    ds_read_b64_tr_b16 v[56:57], v11 offset:12288
    v_mfma_f32_16x16x32_bf16 v[100:103], v[28:31], v[216:219], v[100:103]
    ds_read_b64_tr_b16 v[58:59], v11 offset:13056
    v_mfma_f32_16x16x32_bf16 v[124:127], v[24:27], v[196:199], v[124:127]
    ds_read_b64_tr_b16 v[60:61], v11 offset:18432
    v_mfma_f32_16x16x32_bf16 v[124:127], v[28:31], v[220:223], v[124:127]
    ds_read_b64_tr_b16 v[62:63], v11 offset:19200
    v_mfma_f32_16x16x32_bf16 v[148:151], v[24:27], v[200:203], v[148:151]
    v_mfma_f32_16x16x32_bf16 v[148:151], v[28:31], v[240:243], v[148:151]
    v_mfma_f32_16x16x32_bf16 v[172:175], v[24:27], v[204:207], v[172:175]
    v_mfma_f32_16x16x32_bf16 v[172:175], v[28:31], v[244:247], v[172:175]
    s_waitcnt lgkmcnt(12)
    v_mfma_f32_16x16x32_bf16 v[104:107], v[32:35], v[192:195], v[104:107]
    v_mfma_f32_16x16x32_bf16 v[104:107], v[36:39], v[216:219], v[104:107]
    v_mfma_f32_16x16x32_bf16 v[128:131], v[32:35], v[196:199], v[128:131]
    v_mfma_f32_16x16x32_bf16 v[128:131], v[36:39], v[220:223], v[128:131]
    v_mfma_f32_16x16x32_bf16 v[152:155], v[32:35], v[200:203], v[152:155]
    v_mfma_f32_16x16x32_bf16 v[152:155], v[36:39], v[240:243], v[152:155]
    v_mfma_f32_16x16x32_bf16 v[176:179], v[32:35], v[204:207], v[176:179]
    v_mfma_f32_16x16x32_bf16 v[176:179], v[36:39], v[244:247], v[176:179]
    s_waitcnt lgkmcnt(0)
    s_barrier
    v_mfma_f32_16x16x32_bf16 v[108:111], v[40:43], v[192:195], v[108:111]
    ds_read_b64_tr_b16 v[16:17], v6 offset:0
    v_mfma_f32_16x16x32_bf16 v[108:111], v[44:47], v[216:219], v[108:111]
    ds_read_b64_tr_b16 v[18:19], v6 offset:768
    v_mfma_f32_16x16x32_bf16 v[132:135], v[40:43], v[196:199], v[132:135]
    ds_read_b64_tr_b16 v[20:21], v6 offset:6144
    v_mfma_f32_16x16x32_bf16 v[132:135], v[44:47], v[220:223], v[132:135]
    ds_read_b64_tr_b16 v[22:23], v6 offset:6912
    v_mfma_f32_16x16x32_bf16 v[156:159], v[40:43], v[200:203], v[156:159]
    ds_read_b128 v[64:67], v2 offset:0
    v_mfma_f32_16x16x32_bf16 v[156:159], v[44:47], v[240:243], v[156:159]
    ds_read_b128 v[80:83], v3 offset:0
    v_mfma_f32_16x16x32_bf16 v[180:183], v[40:43], v[204:207], v[180:183]
    ds_read_b128 v[68:71], v2 offset:2048
    v_mfma_f32_16x16x32_bf16 v[180:183], v[44:47], v[244:247], v[180:183]
    ds_read_b128 v[84:87], v3 offset:2048
    v_mfma_f32_16x16x32_bf16 v[112:115], v[48:51], v[192:195], v[112:115]
    ds_read_b128 v[72:75], v2 offset:4096
    v_mfma_f32_16x16x32_bf16 v[112:115], v[52:55], v[216:219], v[112:115]
    ds_read_b128 v[88:91], v3 offset:4096
    v_mfma_f32_16x16x32_bf16 v[136:139], v[48:51], v[196:199], v[136:139]
    ds_read_b128 v[76:79], v2 offset:6144
    v_mfma_f32_16x16x32_bf16 v[136:139], v[52:55], v[220:223], v[136:139]
    ds_read_b128 v[92:95], v3 offset:6144
    v_mfma_f32_16x16x32_bf16 v[160:163], v[48:51], v[200:203], v[160:163]
    ds_read_b64_tr_b16 v[24:25], v6 offset:12288
    v_mfma_f32_16x16x32_bf16 v[160:163], v[52:55], v[240:243], v[160:163]
    ds_read_b64_tr_b16 v[26:27], v6 offset:13056
    v_mfma_f32_16x16x32_bf16 v[184:187], v[48:51], v[204:207], v[184:187]
    ds_read_b64_tr_b16 v[28:29], v6 offset:18432
    v_mfma_f32_16x16x32_bf16 v[184:187], v[52:55], v[244:247], v[184:187]
    ds_read_b64_tr_b16 v[30:31], v6 offset:19200
    v_mfma_f32_16x16x32_bf16 v[116:119], v[56:59], v[192:195], v[116:119]
    ds_read_b64_tr_b16 v[32:33], v7 offset:0
    v_mfma_f32_16x16x32_bf16 v[116:119], v[60:63], v[216:219], v[116:119]
    ds_read_b64_tr_b16 v[34:35], v7 offset:768
    v_mfma_f32_16x16x32_bf16 v[140:143], v[56:59], v[196:199], v[140:143]
    ds_read_b64_tr_b16 v[36:37], v7 offset:6144
    v_mfma_f32_16x16x32_bf16 v[140:143], v[60:63], v[220:223], v[140:143]
    ds_read_b64_tr_b16 v[38:39], v7 offset:6912
    v_mfma_f32_16x16x32_bf16 v[164:167], v[56:59], v[200:203], v[164:167]
    v_mfma_f32_16x16x32_bf16 v[164:167], v[60:63], v[240:243], v[164:167]
    v_mfma_f32_16x16x32_bf16 v[188:191], v[56:59], v[204:207], v[188:191]
    v_mfma_f32_16x16x32_bf16 v[188:191], v[60:63], v[244:247], v[188:191]
    s_waitcnt lgkmcnt(4)
    v_mfma_f32_16x16x32_bf16 v[96:99], v[16:19], v[64:67], v[96:99]
    ds_read_b64_tr_b16 v[40:41], v7 offset:12288
    ds_read_b64_tr_b16 v[42:43], v7 offset:13056
    v_mfma_f32_16x16x32_bf16 v[96:99], v[20:23], v[80:83], v[96:99]
    ds_read_b64_tr_b16 v[44:45], v7 offset:18432
    ds_read_b64_tr_b16 v[46:47], v7 offset:19200
    v_mfma_f32_16x16x32_bf16 v[120:123], v[16:19], v[68:71], v[120:123]
    ds_read_b64_tr_b16 v[48:49], v8 offset:0
    ds_read_b64_tr_b16 v[50:51], v8 offset:768
    v_mfma_f32_16x16x32_bf16 v[120:123], v[20:23], v[84:87], v[120:123]
    ds_read_b64_tr_b16 v[52:53], v8 offset:6144
    ds_read_b64_tr_b16 v[54:55], v8 offset:6912
    v_mfma_f32_16x16x32_bf16 v[100:103], v[24:27], v[64:67], v[100:103]
    ds_read_b64_tr_b16 v[56:57], v8 offset:12288
    ds_read_b64_tr_b16 v[58:59], v8 offset:13056
    v_mfma_f32_16x16x32_bf16 v[100:103], v[28:31], v[80:83], v[100:103]
    ds_read_b64_tr_b16 v[60:61], v8 offset:18432
    ds_read_b64_tr_b16 v[62:63], v8 offset:19200
    v_mfma_f32_16x16x32_bf16 v[124:127], v[24:27], v[68:71], v[124:127]
    v_mfma_f32_16x16x32_bf16 v[124:127], v[28:31], v[84:87], v[124:127]
    s_load_dword s65, s[14:15], 0
    v_mfma_f32_16x16x32_bf16 v[144:147], v[16:19], v[72:75], v[144:147]
    v_mfma_f32_16x16x32_bf16 v[144:147], v[20:23], v[88:91], v[144:147]
    v_mfma_f32_16x16x32_bf16 v[168:171], v[16:19], v[76:79], v[168:171]
    v_mfma_f32_16x16x32_bf16 v[168:171], v[20:23], v[92:95], v[168:171]
    s_waitcnt lgkmcnt(0)
    s_barrier
    s_mov_b32 s66, 0
    s_cmp_lg_u32 s65, 0
    s_cbranch_scc1 L_havenonce
L_nloop:
    buffer_load_dword v14, v13, s[72:75], 0 offen sc1
    s_waitcnt vmcnt(0)
    v_readfirstlane_b32 s65, v14
    s_add_u32 s66, s66, 1
    s_cmp_gt_u32 s66, 1048576
    s_cbranch_scc1 L_havenonce
    s_cmp_eq_u32 s65, 0
    s_cbranch_scc1 L_nloop
L_havenonce:
    s_mov_b32 s86, 0
    s_mov_b32 s87, 128
    s_mov_b32 s88, 256
    v_mov_b32 v2, s65
    v_mfma_f32_16x16x32_bf16 v[148:151], v[24:27], v[72:75], v[148:151]
    v_mfma_f32_16x16x32_bf16 v[148:151], v[28:31], v[88:91], v[148:151]
    v_mfma_f32_16x16x32_bf16 v[172:175], v[24:27], v[76:79], v[172:175]
    v_mfma_f32_16x16x32_bf16 v[172:175], v[28:31], v[92:95], v[172:175]
    v_pk_mul_f32 v[192:193], v[96:97], s[82:83]
    v_mfma_f32_16x16x32_bf16 v[104:107], v[32:35], v[64:67], v[104:107]
    v_pk_mul_f32 v[194:195], v[98:99], s[82:83]
    v_pk_mul_f32 v[196:197], v[120:121], s[82:83]
    v_pk_mul_f32 v[198:199], v[122:123], s[82:83]
    v_mfma_f32_16x16x32_bf16 v[104:107], v[36:39], v[80:83], v[104:107]
    v_exp_f32 v192, v192
    v_exp_f32 v193, v193
    v_exp_f32 v194, v194
    v_mfma_f32_16x16x32_bf16 v[128:131], v[32:35], v[68:71], v[128:131]
    v_exp_f32 v195, v195
    v_exp_f32 v196, v196
    v_exp_f32 v197, v197
    v_mfma_f32_16x16x32_bf16 v[128:131], v[36:39], v[84:87], v[128:131]
    v_exp_f32 v198, v198
    v_exp_f32 v199, v199
    v_pk_add_f32 v[192:193], v[192:193], s[84:85]
    v_mfma_f32_16x16x32_bf16 v[108:111], v[40:43], v[64:67], v[108:111]
    v_pk_add_f32 v[194:195], v[194:195], s[84:85]
    v_pk_add_f32 v[196:197], v[196:197], s[84:85]
    v_pk_add_f32 v[198:199], v[198:199], s[84:85]
    v_mfma_f32_16x16x32_bf16 v[108:111], v[44:47], v[80:83], v[108:111]
    v_rcp_f32 v192, v192
    v_rcp_f32 v193, v193
    v_rcp_f32 v194, v194
    v_mfma_f32_16x16x32_bf16 v[132:135], v[40:43], v[68:71], v[132:135]
    v_rcp_f32 v195, v195
    v_rcp_f32 v196, v196
    v_rcp_f32 v197, v197
    v_mfma_f32_16x16x32_bf16 v[132:135], v[44:47], v[84:87], v[132:135]
    v_rcp_f32 v198, v198
    v_rcp_f32 v199, v199
    v_pk_mul_f32 v[192:193], v[192:193], v[100:101]
    v_pk_mul_f32 v[194:195], v[194:195], v[102:103]
    v_pk_mul_f32 v[196:197], v[196:197], v[124:125]
    v_pk_mul_f32 v[198:199], v[198:199], v[126:127]
    v_cvt_pk_bf16_f32 v224, v192, v193
    v_cvt_pk_bf16_f32 v225, v194, v195
    v_cvt_pk_bf16_f32 v226, v196, v197
    v_cvt_pk_bf16_f32 v227, v198, v199
    s_nop 1
    v_permlane32_swap_b32 v224, v226
    v_permlane32_swap_b32 v225, v227
    buffer_store_dwordx4 v[224:227], v12, s[32:35], s76 offen sc1
    v_pk_mul_f32 v[200:201], v[144:145], s[82:83]
    v_mfma_f32_16x16x32_bf16 v[152:155], v[32:35], v[72:75], v[152:155]
    v_pk_mul_f32 v[202:203], v[146:147], s[82:83]
    v_pk_mul_f32 v[204:205], v[168:169], s[82:83]
    v_pk_mul_f32 v[206:207], v[170:171], s[82:83]
    v_mfma_f32_16x16x32_bf16 v[152:155], v[36:39], v[88:91], v[152:155]
    v_exp_f32 v200, v200
    v_exp_f32 v201, v201
    v_exp_f32 v202, v202
    v_mfma_f32_16x16x32_bf16 v[176:179], v[32:35], v[76:79], v[176:179]
    v_exp_f32 v203, v203
    v_exp_f32 v204, v204
    v_exp_f32 v205, v205
    v_mfma_f32_16x16x32_bf16 v[176:179], v[36:39], v[92:95], v[176:179]
    v_exp_f32 v206, v206
    v_exp_f32 v207, v207
    v_pk_add_f32 v[200:201], v[200:201], s[84:85]
    v_mfma_f32_16x16x32_bf16 v[156:159], v[40:43], v[72:75], v[156:159]
    v_pk_add_f32 v[202:203], v[202:203], s[84:85]
    v_pk_add_f32 v[204:205], v[204:205], s[84:85]
    v_pk_add_f32 v[206:207], v[206:207], s[84:85]
    v_mfma_f32_16x16x32_bf16 v[156:159], v[44:47], v[88:91], v[156:159]
    v_rcp_f32 v200, v200
    v_rcp_f32 v201, v201
    v_rcp_f32 v202, v202
    v_mfma_f32_16x16x32_bf16 v[180:183], v[40:43], v[76:79], v[180:183]
    v_rcp_f32 v203, v203
    v_rcp_f32 v204, v204
    v_rcp_f32 v205, v205
    v_mfma_f32_16x16x32_bf16 v[180:183], v[44:47], v[92:95], v[180:183]
    v_rcp_f32 v206, v206
    v_rcp_f32 v207, v207
    v_pk_mul_f32 v[200:201], v[200:201], v[148:149]
    v_pk_mul_f32 v[202:203], v[202:203], v[150:151]
    v_pk_mul_f32 v[204:205], v[204:205], v[172:173]
    v_pk_mul_f32 v[206:207], v[206:207], v[174:175]
    v_cvt_pk_bf16_f32 v228, v200, v201
    v_cvt_pk_bf16_f32 v229, v202, v203
    v_cvt_pk_bf16_f32 v230, v204, v205
    v_cvt_pk_bf16_f32 v231, v206, v207
    s_nop 1
    v_permlane32_swap_b32 v228, v230
    v_permlane32_swap_b32 v229, v231
    buffer_store_dwordx4 v[228:231], v12, s[32:35], s77 offen sc1
    v_pk_mul_f32 v[192:193], v[104:105], s[82:83]
    v_mfma_f32_16x16x32_bf16 v[112:115], v[48:51], v[64:67], v[112:115]
    v_pk_mul_f32 v[194:195], v[106:107], s[82:83]
    v_pk_mul_f32 v[196:197], v[128:129], s[82:83]
    v_pk_mul_f32 v[198:199], v[130:131], s[82:83]
    v_mfma_f32_16x16x32_bf16 v[112:115], v[52:55], v[80:83], v[112:115]
    v_exp_f32 v192, v192
    v_exp_f32 v193, v193
    v_exp_f32 v194, v194
    v_mfma_f32_16x16x32_bf16 v[136:139], v[48:51], v[68:71], v[136:139]
    v_exp_f32 v195, v195
    v_exp_f32 v196, v196
    v_exp_f32 v197, v197
    v_mfma_f32_16x16x32_bf16 v[136:139], v[52:55], v[84:87], v[136:139]
    v_exp_f32 v198, v198
    v_exp_f32 v199, v199
    v_pk_add_f32 v[192:193], v[192:193], s[84:85]
    v_mfma_f32_16x16x32_bf16 v[116:119], v[56:59], v[64:67], v[116:119]
    v_pk_add_f32 v[194:195], v[194:195], s[84:85]
    v_pk_add_f32 v[196:197], v[196:197], s[84:85]
    v_pk_add_f32 v[198:199], v[198:199], s[84:85]
    v_mfma_f32_16x16x32_bf16 v[116:119], v[60:63], v[80:83], v[116:119]
    v_rcp_f32 v192, v192
    v_rcp_f32 v193, v193
    v_rcp_f32 v194, v194
    v_mfma_f32_16x16x32_bf16 v[140:143], v[56:59], v[68:71], v[140:143]
    v_rcp_f32 v195, v195
    v_rcp_f32 v196, v196
    v_rcp_f32 v197, v197
    v_mfma_f32_16x16x32_bf16 v[140:143], v[60:63], v[84:87], v[140:143]
    v_rcp_f32 v198, v198
    v_rcp_f32 v199, v199
    v_pk_mul_f32 v[192:193], v[192:193], v[108:109]
    v_pk_mul_f32 v[194:195], v[194:195], v[110:111]
    v_pk_mul_f32 v[196:197], v[196:197], v[132:133]
    v_pk_mul_f32 v[198:199], v[198:199], v[134:135]
    v_cvt_pk_bf16_f32 v232, v192, v193
    v_cvt_pk_bf16_f32 v233, v194, v195
    v_cvt_pk_bf16_f32 v234, v196, v197
    v_cvt_pk_bf16_f32 v235, v198, v199
    s_nop 1
    v_permlane32_swap_b32 v232, v234
    v_permlane32_swap_b32 v233, v235
    buffer_store_dwordx4 v[232:235], v12, s[32:35], s78 offen sc1
    v_pk_mul_f32 v[200:201], v[152:153], s[82:83]
    v_mfma_f32_16x16x32_bf16 v[160:163], v[48:51], v[72:75], v[160:163]
    v_pk_mul_f32 v[202:203], v[154:155], s[82:83]
    v_pk_mul_f32 v[204:205], v[176:177], s[82:83]
    v_pk_mul_f32 v[206:207], v[178:179], s[82:83]
    v_mfma_f32_16x16x32_bf16 v[160:163], v[52:55], v[88:91], v[160:163]
    v_exp_f32 v200, v200
    v_exp_f32 v201, v201
    v_exp_f32 v202, v202
    v_mfma_f32_16x16x32_bf16 v[184:187], v[48:51], v[76:79], v[184:187]
    v_exp_f32 v203, v203
    v_exp_f32 v204, v204
    v_exp_f32 v205, v205
    v_mfma_f32_16x16x32_bf16 v[184:187], v[52:55], v[92:95], v[184:187]
    v_exp_f32 v206, v206
    v_exp_f32 v207, v207
    v_pk_add_f32 v[200:201], v[200:201], s[84:85]
    v_mfma_f32_16x16x32_bf16 v[164:167], v[56:59], v[72:75], v[164:167]
    v_pk_add_f32 v[202:203], v[202:203], s[84:85]
    v_pk_add_f32 v[204:205], v[204:205], s[84:85]
    v_pk_add_f32 v[206:207], v[206:207], s[84:85]
    v_mfma_f32_16x16x32_bf16 v[164:167], v[60:63], v[88:91], v[164:167]
    v_rcp_f32 v200, v200
    v_rcp_f32 v201, v201
    v_rcp_f32 v202, v202
    v_mfma_f32_16x16x32_bf16 v[188:191], v[56:59], v[76:79], v[188:191]
    v_rcp_f32 v203, v203
    v_rcp_f32 v204, v204
    v_rcp_f32 v205, v205
    v_mfma_f32_16x16x32_bf16 v[188:191], v[60:63], v[92:95], v[188:191]
    v_rcp_f32 v206, v206
    v_rcp_f32 v207, v207
    v_pk_mul_f32 v[200:201], v[200:201], v[156:157]
    v_pk_mul_f32 v[202:203], v[202:203], v[158:159]
    v_pk_mul_f32 v[204:205], v[204:205], v[180:181]
    v_pk_mul_f32 v[206:207], v[206:207], v[182:183]
    v_cvt_pk_bf16_f32 v236, v200, v201
    v_cvt_pk_bf16_f32 v237, v202, v203
    v_cvt_pk_bf16_f32 v238, v204, v205
    v_cvt_pk_bf16_f32 v239, v206, v207
    s_nop 1
    v_permlane32_swap_b32 v236, v238
    v_permlane32_swap_b32 v237, v239
    buffer_store_dwordx4 v[236:239], v12, s[32:35], s79 offen sc1
    v_pk_mul_f32 v[192:193], v[112:113], s[82:83]
    v_pk_mul_f32 v[194:195], v[114:115], s[82:83]
    v_pk_mul_f32 v[196:197], v[136:137], s[82:83]
    v_pk_mul_f32 v[198:199], v[138:139], s[82:83]
    v_exp_f32 v192, v192
    v_exp_f32 v193, v193
    v_exp_f32 v194, v194
    v_exp_f32 v195, v195
    v_exp_f32 v196, v196
    v_exp_f32 v197, v197
    v_exp_f32 v198, v198
    v_exp_f32 v199, v199
    v_pk_add_f32 v[192:193], v[192:193], s[84:85]
    v_pk_add_f32 v[194:195], v[194:195], s[84:85]
    v_pk_add_f32 v[196:197], v[196:197], s[84:85]
    v_pk_add_f32 v[198:199], v[198:199], s[84:85]
    v_rcp_f32 v192, v192
    v_rcp_f32 v193, v193
    v_rcp_f32 v194, v194
    v_rcp_f32 v195, v195
    v_rcp_f32 v196, v196
    v_rcp_f32 v197, v197
    v_rcp_f32 v198, v198
    v_rcp_f32 v199, v199
    v_pk_mul_f32 v[192:193], v[192:193], v[116:117]
    v_pk_mul_f32 v[194:195], v[194:195], v[118:119]
    v_pk_mul_f32 v[196:197], v[196:197], v[140:141]
    v_pk_mul_f32 v[198:199], v[198:199], v[142:143]
    v_cvt_pk_bf16_f32 v240, v192, v193
    v_cvt_pk_bf16_f32 v241, v194, v195
    v_cvt_pk_bf16_f32 v242, v196, v197
    v_cvt_pk_bf16_f32 v243, v198, v199
    s_nop 1
    v_permlane32_swap_b32 v240, v242
    v_permlane32_swap_b32 v241, v243
    buffer_store_dwordx4 v[240:243], v12, s[32:35], s80 offen sc1
    s_waitcnt vmcnt(3)
    buffer_store_dword v2, v208, s[32:35], s86 offen sc1
    v_pk_mul_f32 v[200:201], v[160:161], s[82:83]
    v_pk_mul_f32 v[202:203], v[162:163], s[82:83]
    v_pk_mul_f32 v[204:205], v[184:185], s[82:83]
    v_pk_mul_f32 v[206:207], v[186:187], s[82:83]
    v_exp_f32 v200, v200
    v_exp_f32 v201, v201
    v_exp_f32 v202, v202
    v_exp_f32 v203, v203
    v_exp_f32 v204, v204
    v_exp_f32 v205, v205
    v_exp_f32 v206, v206
    v_exp_f32 v207, v207
    v_pk_add_f32 v[200:201], v[200:201], s[84:85]
    v_pk_add_f32 v[202:203], v[202:203], s[84:85]
    v_pk_add_f32 v[204:205], v[204:205], s[84:85]
    v_pk_add_f32 v[206:207], v[206:207], s[84:85]
    v_rcp_f32 v200, v200
    v_rcp_f32 v201, v201
    v_rcp_f32 v202, v202
    v_rcp_f32 v203, v203
    v_rcp_f32 v204, v204
    v_rcp_f32 v205, v205
    v_rcp_f32 v206, v206
    v_rcp_f32 v207, v207
    v_pk_mul_f32 v[200:201], v[200:201], v[164:165]
    v_pk_mul_f32 v[202:203], v[202:203], v[166:167]
    v_pk_mul_f32 v[204:205], v[204:205], v[188:189]
    v_pk_mul_f32 v[206:207], v[206:207], v[190:191]
    v_cvt_pk_bf16_f32 v244, v200, v201
    v_cvt_pk_bf16_f32 v245, v202, v203
    v_cvt_pk_bf16_f32 v246, v204, v205
    v_cvt_pk_bf16_f32 v247, v206, v207
    s_nop 1
    v_permlane32_swap_b32 v244, v246
    v_permlane32_swap_b32 v245, v247
    buffer_store_dwordx4 v[244:247], v12, s[32:35], s81 offen sc1
    s_waitcnt vmcnt(3)
    buffer_store_dword v2, v208, s[32:35], s87 offen sc1
    s_barrier
    ds_read_b64_tr_b16 v[16:17], v213 offset:40960
    ds_read_b64_tr_b16 v[18:19], v213 offset:42240
    ds_read_b64_tr_b16 v[20:21], v213 offset:40992
    ds_read_b64_tr_b16 v[22:23], v213 offset:42272
    ds_read_b64_tr_b16 v[24:25], v213 offset:41024
    ds_read_b64_tr_b16 v[26:27], v213 offset:42304
    ds_read_b64_tr_b16 v[28:29], v213 offset:41056
    ds_read_b64_tr_b16 v[30:31], v213 offset:42336
    ds_read_b64_tr_b16 v[32:33], v213 offset:41088
    ds_read_b64_tr_b16 v[34:35], v213 offset:42368
    ds_read_b64_tr_b16 v[36:37], v213 offset:46080
    ds_read_b64_tr_b16 v[38:39], v213 offset:47360
    ds_read_b64_tr_b16 v[40:41], v213 offset:46112
    ds_read_b64_tr_b16 v[42:43], v213 offset:47392
    ds_read_b64_tr_b16 v[44:45], v213 offset:46144
    ds_read_b64_tr_b16 v[46:47], v213 offset:47424
    ds_read_b64_tr_b16 v[48:49], v213 offset:46176
    ds_read_b64_tr_b16 v[50:51], v213 offset:47456
    ds_read_b64_tr_b16 v[52:53], v213 offset:46208
    ds_read_b64_tr_b16 v[54:55], v213 offset:47488
    ds_read_b64_tr_b16 v[56:57], v213 offset:51200
    ds_read_b64_tr_b16 v[58:59], v213 offset:52480
    ds_read_b64_tr_b16 v[60:61], v213 offset:51232
    ds_read_b64_tr_b16 v[62:63], v213 offset:52512
    ds_read_b64_tr_b16 v[64:65], v213 offset:51264
    ds_read_b64_tr_b16 v[66:67], v213 offset:52544
    ds_read_b64_tr_b16 v[68:69], v213 offset:51296
    ds_read_b64_tr_b16 v[70:71], v213 offset:52576
    ds_read_b64_tr_b16 v[72:73], v213 offset:51328
    ds_read_b64_tr_b16 v[74:75], v213 offset:52608
    ds_read_b64_tr_b16 v[76:77], v213 offset:56320
    ds_read_b64_tr_b16 v[78:79], v213 offset:57600
    ds_read_b64_tr_b16 v[80:81], v213 offset:56352
    ds_read_b64_tr_b16 v[82:83], v213 offset:57632
    ds_read_b64_tr_b16 v[84:85], v213 offset:56384
    ds_read_b64_tr_b16 v[86:87], v213 offset:57664
    ds_read_b64_tr_b16 v[88:89], v213 offset:56416
    ds_read_b64_tr_b16 v[90:91], v213 offset:57696
    ds_read_b64_tr_b16 v[92:93], v213 offset:56448
    ds_read_b64_tr_b16 v[94:95], v213 offset:57728
    ds_read_b64_tr_b16 v[96:97], v212 offset:40960
    ds_read_b64_tr_b16 v[98:99], v212 offset:42240
    ds_read_b64_tr_b16 v[100:101], v212 offset:40992
    ds_read_b64_tr_b16 v[102:103], v212 offset:42272
    ds_read_b64_tr_b16 v[104:105], v212 offset:41024
    ds_read_b64_tr_b16 v[106:107], v212 offset:42304
    ds_read_b64_tr_b16 v[108:109], v212 offset:41056
    ds_read_b64_tr_b16 v[110:111], v212 offset:42336
    ds_read_b64_tr_b16 v[112:113], v212 offset:41088
    ds_read_b64_tr_b16 v[114:115], v212 offset:42368
    ds_read_b64_tr_b16 v[116:117], v212 offset:46080
    ds_read_b64_tr_b16 v[118:119], v212 offset:47360
    ds_read_b64_tr_b16 v[120:121], v212 offset:46112
    ds_read_b64_tr_b16 v[122:123], v212 offset:47392
    ds_read_b64_tr_b16 v[124:125], v212 offset:46144
    ds_read_b64_tr_b16 v[126:127], v212 offset:47424
    ds_read_b64_tr_b16 v[128:129], v212 offset:46176
    ds_read_b64_tr_b16 v[130:131], v212 offset:47456
    ds_read_b64_tr_b16 v[132:133], v212 offset:46208
    ds_read_b64_tr_b16 v[134:135], v212 offset:47488
    ds_read_b64_tr_b16 v[136:137], v212 offset:51200
    ds_read_b64_tr_b16 v[138:139], v212 offset:52480
    ds_read_b64_tr_b16 v[140:141], v212 offset:51232
    ds_read_b64_tr_b16 v[142:143], v212 offset:52512
    ds_read_b64_tr_b16 v[144:145], v212 offset:51264
    ds_read_b64_tr_b16 v[146:147], v212 offset:52544
    ds_read_b64_tr_b16 v[148:149], v212 offset:51296
    ds_read_b64_tr_b16 v[150:151], v212 offset:52576
    ds_read_b64_tr_b16 v[152:153], v212 offset:51328
    ds_read_b64_tr_b16 v[154:155], v212 offset:52608
    ds_read_b64_tr_b16 v[156:157], v212 offset:56320
    ds_read_b64_tr_b16 v[158:159], v212 offset:57600
    ds_read_b64_tr_b16 v[160:161], v212 offset:56352
    ds_read_b64_tr_b16 v[162:163], v212 offset:57632
    ds_read_b64_tr_b16 v[164:165], v212 offset:56384
    ds_read_b64_tr_b16 v[166:167], v212 offset:57664
    ds_read_b64_tr_b16 v[168:169], v212 offset:56416
    ds_read_b64_tr_b16 v[170:171], v212 offset:57696
    ds_read_b64_tr_b16 v[172:173], v212 offset:56448
    ds_read_b64_tr_b16 v[174:175], v212 offset:57728
    s_waitcnt vmcnt(1)
    buffer_store_dword v2, v208, s[32:35], s88 offen sc1
    s_waitcnt lgkmcnt(0)
    s_barrier
    buffer_load_dword v5, v209, s[32:35], s86 offen sc1
    s_waitcnt vmcnt(0)
    s_mov_b32 s66, 0
L_chk0:
    v_cmp_ne_u32 vcc, s65, v5
    s_add_u32 s66, s66, 1
    s_nop 0
    s_cmp_eq_u64 vcc, 0
    s_cbranch_scc1 L_go0
    s_cmp_gt_u32 s66, 1048576
    s_cbranch_scc1 L_go0
    s_sleep 4
    buffer_load_dword v5, v209, s[32:35], s86 offen sc1
    s_waitcnt vmcnt(0)
    s_branch L_chk0
L_go0:
    s_xor_b32 s58, s89, 0
    s_lshl_b32 s58, s58, 12
    buffer_load_dwordx4 v[176:179], v210, s[32:35], s58 offen offset:0 sc1
    buffer_load_dwordx4 v[180:183], v211, s[32:35], s58 offen offset:0 sc1
    buffer_load_dwordx4 v[184:187], v210, s[32:35], s58 offen offset:1024 sc1
    buffer_load_dwordx4 v[188:191], v211, s[32:35], s58 offen offset:1024 sc1
    buffer_load_dwordx4 v[192:195], v210, s[32:35], s58 offen offset:2048 sc1
    buffer_load_dwordx4 v[196:199], v211, s[32:35], s58 offen offset:2048 sc1
    buffer_load_dwordx4 v[200:203], v210, s[32:35], s58 offen offset:3072 sc1
    buffer_load_dwordx4 v[204:207], v211, s[32:35], s58 offen offset:3072 sc1
    s_xor_b32 s58, s89, 1
    s_lshl_b32 s58, s58, 12
    buffer_load_dwordx4 v[6:9], v210, s[32:35], s58 offen offset:0 sc1
    buffer_load_dwordx4 v[10:13], v211, s[32:35], s58 offen offset:0 sc1
    s_waitcnt vmcnt(8)
    v_mov_b32 v5, 0
    buffer_load_dword v5, v209, s[32:35], s87 offen sc1
    v_mfma_f32_16x16x32_bf16 v[216:219], v[16:19], v[176:179], 0
    v_mfma_f32_16x16x32_bf16 v[236:239], v[16:19], v[180:183], 0
    v_mfma_f32_16x16x32_bf16 v[220:223], v[20:23], v[176:179], 0
    v_mfma_f32_16x16x32_bf16 v[240:243], v[20:23], v[180:183], 0
    v_mfma_f32_16x16x32_bf16 v[224:227], v[24:27], v[176:179], 0
    v_mfma_f32_16x16x32_bf16 v[244:247], v[24:27], v[180:183], 0
    v_mfma_f32_16x16x32_bf16 v[228:231], v[28:31], v[176:179], 0
    v_mfma_f32_16x16x32_bf16 v[248:251], v[28:31], v[180:183], 0
    v_mfma_f32_16x16x32_bf16 v[232:235], v[32:35], v[176:179], 0
    v_mfma_f32_16x16x32_bf16 v[252:255], v[32:35], v[180:183], 0
    buffer_load_dwordx4 v[176:179], v210, s[32:35], s58 offen offset:1024 sc1
    buffer_load_dwordx4 v[180:183], v211, s[32:35], s58 offen offset:1024 sc1
    s_waitcnt vmcnt(9)
    v_mfma_f32_16x16x32_bf16 v[216:219], v[36:39], v[184:187], v[216:219]
    v_mfma_f32_16x16x32_bf16 v[236:239], v[36:39], v[188:191], v[236:239]
    v_mfma_f32_16x16x32_bf16 v[220:223], v[40:43], v[184:187], v[220:223]
    v_mfma_f32_16x16x32_bf16 v[240:243], v[40:43], v[188:191], v[240:243]
    v_mfma_f32_16x16x32_bf16 v[224:227], v[44:47], v[184:187], v[224:227]
    v_mfma_f32_16x16x32_bf16 v[244:247], v[44:47], v[188:191], v[244:247]
    v_mfma_f32_16x16x32_bf16 v[228:231], v[48:51], v[184:187], v[228:231]
    v_mfma_f32_16x16x32_bf16 v[248:251], v[48:51], v[188:191], v[248:251]
    v_mfma_f32_16x16x32_bf16 v[232:235], v[52:55], v[184:187], v[232:235]
    v_mfma_f32_16x16x32_bf16 v[252:255], v[52:55], v[188:191], v[252:255]
    buffer_load_dwordx4 v[184:187], v210, s[32:35], s58 offen offset:2048 sc1
    buffer_load_dwordx4 v[188:191], v211, s[32:35], s58 offen offset:2048 sc1
    s_waitcnt vmcnt(9)
    v_mfma_f32_16x16x32_bf16 v[216:219], v[56:59], v[192:195], v[216:219]
    v_mfma_f32_16x16x32_bf16 v[236:239], v[56:59], v[196:199], v[236:239]
    v_mfma_f32_16x16x32_bf16 v[220:223], v[60:63], v[192:195], v[220:223]
    v_mfma_f32_16x16x32_bf16 v[240:243], v[60:63], v[196:199], v[240:243]
    v_mfma_f32_16x16x32_bf16 v[224:227], v[64:67], v[192:195], v[224:227]
    v_mfma_f32_16x16x32_bf16 v[244:247], v[64:67], v[196:199], v[244:247]
    v_mfma_f32_16x16x32_bf16 v[228:231], v[68:71], v[192:195], v[228:231]
    v_mfma_f32_16x16x32_bf16 v[248:251], v[68:71], v[196:199], v[248:251]
    v_mfma_f32_16x16x32_bf16 v[232:235], v[72:75], v[192:195], v[232:235]
    v_mfma_f32_16x16x32_bf16 v[252:255], v[72:75], v[196:199], v[252:255]
    buffer_load_dwordx4 v[192:195], v210, s[32:35], s58 offen offset:3072 sc1
    buffer_load_dwordx4 v[196:199], v211, s[32:35], s58 offen offset:3072 sc1
    s_waitcnt vmcnt(9)
    v_mfma_f32_16x16x32_bf16 v[216:219], v[76:79], v[200:203], v[216:219]
    v_mfma_f32_16x16x32_bf16 v[236:239], v[76:79], v[204:207], v[236:239]
    v_mfma_f32_16x16x32_bf16 v[220:223], v[80:83], v[200:203], v[220:223]
    v_mfma_f32_16x16x32_bf16 v[240:243], v[80:83], v[204:207], v[240:243]
    v_mfma_f32_16x16x32_bf16 v[224:227], v[84:87], v[200:203], v[224:227]
    v_mfma_f32_16x16x32_bf16 v[244:247], v[84:87], v[204:207], v[244:247]
    v_mfma_f32_16x16x32_bf16 v[228:231], v[88:91], v[200:203], v[228:231]
    v_mfma_f32_16x16x32_bf16 v[248:251], v[88:91], v[204:207], v[248:251]
    v_mfma_f32_16x16x32_bf16 v[232:235], v[92:95], v[200:203], v[232:235]
    v_mfma_f32_16x16x32_bf16 v[252:255], v[92:95], v[204:207], v[252:255]
    s_waitcnt vmcnt(6)
    s_mov_b32 s66, 0
L_chk1:
    v_cmp_ne_u32 vcc, s65, v5
    s_add_u32 s66, s66, 1
    s_nop 0
    s_cmp_eq_u64 vcc, 0
    s_cbranch_scc1 L_go1
    s_cmp_gt_u32 s66, 1048576
    s_cbranch_scc1 L_go1
    s_sleep 4
    buffer_load_dword v5, v209, s[32:35], s87 offen sc1
    s_waitcnt vmcnt(0)
    s_branch L_chk1
L_go1:
    s_xor_b32 s58, s89, 2
    s_lshl_b32 s58, s58, 12
    buffer_load_dwordx4 v[200:203], v210, s[32:35], s58 offen offset:0 sc1
    buffer_load_dwordx4 v[204:207], v211, s[32:35], s58 offen offset:0 sc1
    s_waitcnt vmcnt(9)
    v_mfma_f32_16x16x32_bf16 v[216:219], v[96:99], v[6:9], v[216:219]
    v_mfma_f32_16x16x32_bf16 v[236:239], v[96:99], v[10:13], v[236:239]
    v_mfma_f32_16x16x32_bf16 v[220:223], v[100:103], v[6:9], v[220:223]
    v_mfma_f32_16x16x32_bf16 v[240:243], v[100:103], v[10:13], v[240:243]
    v_mfma_f32_16x16x32_bf16 v[224:227], v[104:107], v[6:9], v[224:227]
    v_mfma_f32_16x16x32_bf16 v[244:247], v[104:107], v[10:13], v[244:247]
    v_mfma_f32_16x16x32_bf16 v[228:231], v[108:111], v[6:9], v[228:231]
    v_mfma_f32_16x16x32_bf16 v[248:251], v[108:111], v[10:13], v[248:251]
    v_mfma_f32_16x16x32_bf16 v[232:235], v[112:115], v[6:9], v[232:235]
    v_mfma_f32_16x16x32_bf16 v[252:255], v[112:115], v[10:13], v[252:255]
    buffer_load_dwordx4 v[6:9], v210, s[32:35], s58 offen offset:1024 sc1
    buffer_load_dwordx4 v[10:13], v211, s[32:35], s58 offen offset:1024 sc1
    s_waitcnt vmcnt(8)
    v_mfma_f32_16x16x32_bf16 v[216:219], v[116:119], v[176:179], v[216:219]
    v_mfma_f32_16x16x32_bf16 v[236:239], v[116:119], v[180:183], v[236:239]
    v_mfma_f32_16x16x32_bf16 v[220:223], v[120:123], v[176:179], v[220:223]
    v_mfma_f32_16x16x32_bf16 v[240:243], v[120:123], v[180:183], v[240:243]
    v_mfma_f32_16x16x32_bf16 v[224:227], v[124:127], v[176:179], v[224:227]
    v_mfma_f32_16x16x32_bf16 v[244:247], v[124:127], v[180:183], v[244:247]
    v_mfma_f32_16x16x32_bf16 v[228:231], v[128:131], v[176:179], v[228:231]
    v_mfma_f32_16x16x32_bf16 v[248:251], v[128:131], v[180:183], v[248:251]
    v_mfma_f32_16x16x32_bf16 v[232:235], v[132:135], v[176:179], v[232:235]
    v_mfma_f32_16x16x32_bf16 v[252:255], v[132:135], v[180:183], v[252:255]
    buffer_load_dwordx4 v[176:179], v210, s[32:35], s58 offen offset:2048 sc1
    buffer_load_dwordx4 v[180:183], v211, s[32:35], s58 offen offset:2048 sc1
    s_waitcnt vmcnt(8)
    v_mfma_f32_16x16x32_bf16 v[216:219], v[136:139], v[184:187], v[216:219]
    ds_read_b64_tr_b16 v[16:17], v213 offset:0
    v_mfma_f32_16x16x32_bf16 v[236:239], v[136:139], v[188:191], v[236:239]
    ds_read_b64_tr_b16 v[18:19], v213 offset:1280
    v_mfma_f32_16x16x32_bf16 v[220:223], v[140:143], v[184:187], v[220:223]
    ds_read_b64_tr_b16 v[20:21], v213 offset:32
    v_mfma_f32_16x16x32_bf16 v[240:243], v[140:143], v[188:191], v[240:243]
    ds_read_b64_tr_b16 v[22:23], v213 offset:1312
    v_mfma_f32_16x16x32_bf16 v[224:227], v[144:147], v[184:187], v[224:227]
    ds_read_b64_tr_b16 v[24:25], v213 offset:64
    v_mfma_f32_16x16x32_bf16 v[244:247], v[144:147], v[188:191], v[244:247]
    ds_read_b64_tr_b16 v[26:27], v213 offset:1344
    v_mfma_f32_16x16x32_bf16 v[228:231], v[148:151], v[184:187], v[228:231]
    ds_read_b64_tr_b16 v[28:29], v213 offset:96
    v_mfma_f32_16x16x32_bf16 v[248:251], v[148:151], v[188:191], v[248:251]
    ds_read_b64_tr_b16 v[30:31], v213 offset:1376
    v_mfma_f32_16x16x32_bf16 v[232:235], v[152:155], v[184:187], v[232:235]
    ds_read_b64_tr_b16 v[32:33], v213 offset:128
    v_mfma_f32_16x16x32_bf16 v[252:255], v[152:155], v[188:191], v[252:255]
    ds_read_b64_tr_b16 v[34:35], v213 offset:1408
    buffer_load_dwordx4 v[184:187], v210, s[32:35], s58 offen offset:3072 sc1
    buffer_load_dwordx4 v[188:191], v211, s[32:35], s58 offen offset:3072 sc1
    v_mov_b32 v5, 0
    buffer_load_dword v5, v209, s[32:35], s88 offen sc1
    s_waitcnt vmcnt(9)
    v_mfma_f32_16x16x32_bf16 v[216:219], v[156:159], v[192:195], v[216:219]
    ds_read_b64_tr_b16 v[36:37], v213 offset:5120
    v_mfma_f32_16x16x32_bf16 v[236:239], v[156:159], v[196:199], v[236:239]
    ds_read_b64_tr_b16 v[38:39], v213 offset:6400
    v_mfma_f32_16x16x32_bf16 v[220:223], v[160:163], v[192:195], v[220:223]
    ds_read_b64_tr_b16 v[40:41], v213 offset:5152
    v_mfma_f32_16x16x32_bf16 v[240:243], v[160:163], v[196:199], v[240:243]
    ds_read_b64_tr_b16 v[42:43], v213 offset:6432
    v_mfma_f32_16x16x32_bf16 v[224:227], v[164:167], v[192:195], v[224:227]
    ds_read_b64_tr_b16 v[44:45], v213 offset:5184
    v_mfma_f32_16x16x32_bf16 v[244:247], v[164:167], v[196:199], v[244:247]
    ds_read_b64_tr_b16 v[46:47], v213 offset:6464
    v_mfma_f32_16x16x32_bf16 v[228:231], v[168:171], v[192:195], v[228:231]
    ds_read_b64_tr_b16 v[48:49], v213 offset:5216
    v_mfma_f32_16x16x32_bf16 v[248:251], v[168:171], v[196:199], v[248:251]
    ds_read_b64_tr_b16 v[50:51], v213 offset:6496
    v_mfma_f32_16x16x32_bf16 v[232:235], v[172:175], v[192:195], v[232:235]
    ds_read_b64_tr_b16 v[52:53], v213 offset:5248
    v_mfma_f32_16x16x32_bf16 v[252:255], v[172:175], v[196:199], v[252:255]
    ds_read_b64_tr_b16 v[54:55], v213 offset:6528
    s_xor_b32 s58, s89, 3
    s_lshl_b32 s58, s58, 12
    buffer_load_dwordx4 v[192:195], v210, s[32:35], s58 offen offset:0 sc1
    buffer_load_dwordx4 v[196:199], v211, s[32:35], s58 offen offset:0 sc1
    s_waitcnt vmcnt(9) lgkmcnt(10)
    v_mfma_f32_16x16x32_bf16 v[216:219], v[16:19], v[200:203], v[216:219]
    ds_read_b64_tr_b16 v[56:57], v213 offset:10240
    v_mfma_f32_16x16x32_bf16 v[236:239], v[16:19], v[204:207], v[236:239]
    ds_read_b64_tr_b16 v[58:59], v213 offset:11520
    v_mfma_f32_16x16x32_bf16 v[220:223], v[20:23], v[200:203], v[220:223]
    ds_read_b64_tr_b16 v[60:61], v213 offset:10272
    v_mfma_f32_16x16x32_bf16 v[240:243], v[20:23], v[204:207], v[240:243]
    ds_read_b64_tr_b16 v[62:63], v213 offset:11552
    v_mfma_f32_16x16x32_bf16 v[224:227], v[24:27], v[200:203], v[224:227]
    ds_read_b64_tr_b16 v[64:65], v213 offset:10304
    v_mfma_f32_16x16x32_bf16 v[244:247], v[24:27], v[204:207], v[244:247]
    ds_read_b64_tr_b16 v[66:67], v213 offset:11584
    v_mfma_f32_16x16x32_bf16 v[228:231], v[28:31], v[200:203], v[228:231]
    ds_read_b64_tr_b16 v[68:69], v213 offset:10336
    v_mfma_f32_16x16x32_bf16 v[248:251], v[28:31], v[204:207], v[248:251]
    ds_read_b64_tr_b16 v[70:71], v213 offset:11616
    v_mfma_f32_16x16x32_bf16 v[232:235], v[32:35], v[200:203], v[232:235]
    ds_read_b64_tr_b16 v[72:73], v213 offset:10368
    v_mfma_f32_16x16x32_bf16 v[252:255], v[32:35], v[204:207], v[252:255]
    ds_read_b64_tr_b16 v[74:75], v213 offset:11648
    buffer_load_dwordx4 v[200:203], v210, s[32:35], s58 offen offset:1024 sc1
    buffer_load_dwordx4 v[204:207], v211, s[32:35], s58 offen offset:1024 sc1
    s_waitcnt vmcnt(9) lgkmcnt(10)
    v_mfma_f32_16x16x32_bf16 v[216:219], v[36:39], v[6:9], v[216:219]
    ds_read_b64_tr_b16 v[76:77], v213 offset:15360
    v_mfma_f32_16x16x32_bf16 v[236:239], v[36:39], v[10:13], v[236:239]
    ds_read_b64_tr_b16 v[78:79], v213 offset:16640
    v_mfma_f32_16x16x32_bf16 v[220:223], v[40:43], v[6:9], v[220:223]
    ds_read_b64_tr_b16 v[80:81], v213 offset:15392
    v_mfma_f32_16x16x32_bf16 v[240:243], v[40:43], v[10:13], v[240:243]
    ds_read_b64_tr_b16 v[82:83], v213 offset:16672
    v_mfma_f32_16x16x32_bf16 v[224:227], v[44:47], v[6:9], v[224:227]
    ds_read_b64_tr_b16 v[84:85], v213 offset:15424
    v_mfma_f32_16x16x32_bf16 v[244:247], v[44:47], v[10:13], v[244:247]
    ds_read_b64_tr_b16 v[86:87], v213 offset:16704
    v_mfma_f32_16x16x32_bf16 v[228:231], v[48:51], v[6:9], v[228:231]
    ds_read_b64_tr_b16 v[88:89], v213 offset:15456
    v_mfma_f32_16x16x32_bf16 v[248:251], v[48:51], v[10:13], v[248:251]
    ds_read_b64_tr_b16 v[90:91], v213 offset:16736
    v_mfma_f32_16x16x32_bf16 v[232:235], v[52:55], v[6:9], v[232:235]
    ds_read_b64_tr_b16 v[92:93], v213 offset:15488
    v_mfma_f32_16x16x32_bf16 v[252:255], v[52:55], v[10:13], v[252:255]
    ds_read_b64_tr_b16 v[94:95], v213 offset:16768
    buffer_load_dwordx4 v[6:9], v210, s[32:35], s58 offen offset:2048 sc1
    buffer_load_dwordx4 v[10:13], v211, s[32:35], s58 offen offset:2048 sc1
    s_waitcnt vmcnt(9) lgkmcnt(10)
    v_mfma_f32_16x16x32_bf16 v[216:219], v[56:59], v[176:179], v[216:219]
    ds_read_b64_tr_b16 v[96:97], v212 offset:0
    v_mfma_f32_16x16x32_bf16 v[236:239], v[56:59], v[180:183], v[236:239]
    ds_read_b64_tr_b16 v[98:99], v212 offset:1280
    v_mfma_f32_16x16x32_bf16 v[220:223], v[60:63], v[176:179], v[220:223]
    ds_read_b64_tr_b16 v[100:101], v212 offset:32
    v_mfma_f32_16x16x32_bf16 v[240:243], v[60:63], v[180:183], v[240:243]
    ds_read_b64_tr_b16 v[102:103], v212 offset:1312
    v_mfma_f32_16x16x32_bf16 v[224:227], v[64:67], v[176:179], v[224:227]
    ds_read_b64_tr_b16 v[104:105], v212 offset:64
    v_mfma_f32_16x16x32_bf16 v[244:247], v[64:67], v[180:183], v[244:247]
    ds_read_b64_tr_b16 v[106:107], v212 offset:1344
    v_mfma_f32_16x16x32_bf16 v[228:231], v[68:71], v[176:179], v[228:231]
    ds_read_b64_tr_b16 v[108:109], v212 offset:96
    v_mfma_f32_16x16x32_bf16 v[248:251], v[68:71], v[180:183], v[248:251]
    ds_read_b64_tr_b16 v[110:111], v212 offset:1376
    v_mfma_f32_16x16x32_bf16 v[232:235], v[72:75], v[176:179], v[232:235]
    ds_read_b64_tr_b16 v[112:113], v212 offset:128
    v_mfma_f32_16x16x32_bf16 v[252:255], v[72:75], v[180:183], v[252:255]
    ds_read_b64_tr_b16 v[114:115], v212 offset:1408
    buffer_load_dwordx4 v[176:179], v210, s[32:35], s58 offen offset:3072 sc1
    buffer_load_dwordx4 v[180:183], v211, s[32:35], s58 offen offset:3072 sc1
    s_waitcnt vmcnt(9) lgkmcnt(10)
    v_mfma_f32_16x16x32_bf16 v[216:219], v[76:79], v[184:187], v[216:219]
    ds_read_b64_tr_b16 v[116:117], v212 offset:5120
    v_mfma_f32_16x16x32_bf16 v[236:239], v[76:79], v[188:191], v[236:239]
    ds_read_b64_tr_b16 v[118:119], v212 offset:6400
    v_mfma_f32_16x16x32_bf16 v[220:223], v[80:83], v[184:187], v[220:223]
    ds_read_b64_tr_b16 v[120:121], v212 offset:5152
    v_mfma_f32_16x16x32_bf16 v[240:243], v[80:83], v[188:191], v[240:243]
    ds_read_b64_tr_b16 v[122:123], v212 offset:6432
    v_mfma_f32_16x16x32_bf16 v[224:227], v[84:87], v[184:187], v[224:227]
    ds_read_b64_tr_b16 v[124:125], v212 offset:5184
    v_mfma_f32_16x16x32_bf16 v[244:247], v[84:87], v[188:191], v[244:247]
    ds_read_b64_tr_b16 v[126:127], v212 offset:6464
    v_mfma_f32_16x16x32_bf16 v[228:231], v[88:91], v[184:187], v[228:231]
    ds_read_b64_tr_b16 v[128:129], v212 offset:5216
    v_mfma_f32_16x16x32_bf16 v[248:251], v[88:91], v[188:191], v[248:251]
    ds_read_b64_tr_b16 v[130:131], v212 offset:6496
    v_mfma_f32_16x16x32_bf16 v[232:235], v[92:95], v[184:187], v[232:235]
    ds_read_b64_tr_b16 v[132:133], v212 offset:5248
    v_mfma_f32_16x16x32_bf16 v[252:255], v[92:95], v[188:191], v[252:255]
    ds_read_b64_tr_b16 v[134:135], v212 offset:6528
    s_waitcnt vmcnt(8)
    s_mov_b32 s66, 0
L_chk2:
    v_cmp_ne_u32 vcc, s65, v5
    s_add_u32 s66, s66, 1
    s_nop 0
    s_cmp_eq_u64 vcc, 0
    s_cbranch_scc1 L_go2
    s_cmp_gt_u32 s66, 1048576
    s_cbranch_scc1 L_go2
    s_sleep 4
    buffer_load_dword v5, v209, s[32:35], s88 offen sc1
    s_waitcnt vmcnt(0)
    s_branch L_chk2
L_go2:
    s_xor_b32 s58, s89, 4
    s_lshl_b32 s58, s58, 12
    buffer_load_dwordx4 v[184:187], v210, s[32:35], s58 offen offset:0 sc1
    buffer_load_dwordx4 v[188:191], v211, s[32:35], s58 offen offset:0 sc1
    s_waitcnt vmcnt(8) lgkmcnt(10)
    v_mfma_f32_16x16x32_bf16 v[216:219], v[96:99], v[192:195], v[216:219]
    ds_read_b64_tr_b16 v[136:137], v212 offset:10240
    v_mfma_f32_16x16x32_bf16 v[236:239], v[96:99], v[196:199], v[236:239]
    ds_read_b64_tr_b16 v[138:139], v212 offset:11520
    v_mfma_f32_16x16x32_bf16 v[220:223], v[100:103], v[192:195], v[220:223]
    ds_read_b64_tr_b16 v[140:141], v212 offset:10272
    v_mfma_f32_16x16x32_bf16 v[240:243], v[100:103], v[196:199], v[240:243]
    ds_read_b64_tr_b16 v[142:143], v212 offset:11552
    v_mfma_f32_16x16x32_bf16 v[224:227], v[104:107], v[192:195], v[224:227]
    ds_read_b64_tr_b16 v[144:145], v212 offset:10304
    v_mfma_f32_16x16x32_bf16 v[244:247], v[104:107], v[196:199], v[244:247]
    ds_read_b64_tr_b16 v[146:147], v212 offset:11584
    v_mfma_f32_16x16x32_bf16 v[228:231], v[108:111], v[192:195], v[228:231]
    ds_read_b64_tr_b16 v[148:149], v212 offset:10336
    v_mfma_f32_16x16x32_bf16 v[248:251], v[108:111], v[196:199], v[248:251]
    ds_read_b64_tr_b16 v[150:151], v212 offset:11616
    v_mfma_f32_16x16x32_bf16 v[232:235], v[112:115], v[192:195], v[232:235]
    ds_read_b64_tr_b16 v[152:153], v212 offset:10368
    v_mfma_f32_16x16x32_bf16 v[252:255], v[112:115], v[196:199], v[252:255]
    ds_read_b64_tr_b16 v[154:155], v212 offset:11648
    buffer_load_dwordx4 v[192:195], v210, s[32:35], s58 offen offset:1024 sc1
    buffer_load_dwordx4 v[196:199], v211, s[32:35], s58 offen offset:1024 sc1
    s_waitcnt vmcnt(8) lgkmcnt(10)
    v_mfma_f32_16x16x32_bf16 v[216:219], v[116:119], v[200:203], v[216:219]
    ds_read_b64_tr_b16 v[156:157], v212 offset:15360
    v_mfma_f32_16x16x32_bf16 v[236:239], v[116:119], v[204:207], v[236:239]
    ds_read_b64_tr_b16 v[158:159], v212 offset:16640
    v_mfma_f32_16x16x32_bf16 v[220:223], v[120:123], v[200:203], v[220:223]
    ds_read_b64_tr_b16 v[160:161], v212 offset:15392
    v_mfma_f32_16x16x32_bf16 v[240:243], v[120:123], v[204:207], v[240:243]
    ds_read_b64_tr_b16 v[162:163], v212 offset:16672
    v_mfma_f32_16x16x32_bf16 v[224:227], v[124:127], v[200:203], v[224:227]
    ds_read_b64_tr_b16 v[164:165], v212 offset:15424
    v_mfma_f32_16x16x32_bf16 v[244:247], v[124:127], v[204:207], v[244:247]
    ds_read_b64_tr_b16 v[166:167], v212 offset:16704
    v_mfma_f32_16x16x32_bf16 v[228:231], v[128:131], v[200:203], v[228:231]
    ds_read_b64_tr_b16 v[168:169], v212 offset:15456
    v_mfma_f32_16x16x32_bf16 v[248:251], v[128:131], v[204:207], v[248:251]
    ds_read_b64_tr_b16 v[170:171], v212 offset:16736
    v_mfma_f32_16x16x32_bf16 v[232:235], v[132:135], v[200:203], v[232:235]
    ds_read_b64_tr_b16 v[172:173], v212 offset:15488
    v_mfma_f32_16x16x32_bf16 v[252:255], v[132:135], v[204:207], v[252:255]
    ds_read_b64_tr_b16 v[174:175], v212 offset:16768
    buffer_load_dwordx4 v[200:203], v210, s[32:35], s58 offen offset:2048 sc1
    buffer_load_dwordx4 v[204:207], v211, s[32:35], s58 offen offset:2048 sc1
    s_barrier
    s_waitcnt vmcnt(8) lgkmcnt(10)
    v_mfma_f32_16x16x32_bf16 v[216:219], v[136:139], v[6:9], v[216:219]
    ds_read_b64_tr_b16 v[16:17], v213 offset:40960
    v_mfma_f32_16x16x32_bf16 v[236:239], v[136:139], v[10:13], v[236:239]
    ds_read_b64_tr_b16 v[18:19], v213 offset:42240
    v_mfma_f32_16x16x32_bf16 v[220:223], v[140:143], v[6:9], v[220:223]
    ds_read_b64_tr_b16 v[20:21], v213 offset:40992
    v_mfma_f32_16x16x32_bf16 v[240:243], v[140:143], v[10:13], v[240:243]
    ds_read_b64_tr_b16 v[22:23], v213 offset:42272
    v_mfma_f32_16x16x32_bf16 v[224:227], v[144:147], v[6:9], v[224:227]
    ds_read_b64_tr_b16 v[24:25], v213 offset:41024
    v_mfma_f32_16x16x32_bf16 v[244:247], v[144:147], v[10:13], v[244:247]
    ds_read_b64_tr_b16 v[26:27], v213 offset:42304
    v_mfma_f32_16x16x32_bf16 v[228:231], v[148:151], v[6:9], v[228:231]
    ds_read_b64_tr_b16 v[28:29], v213 offset:41056
    v_mfma_f32_16x16x32_bf16 v[248:251], v[148:151], v[10:13], v[248:251]
    ds_read_b64_tr_b16 v[30:31], v213 offset:42336
    v_mfma_f32_16x16x32_bf16 v[232:235], v[152:155], v[6:9], v[232:235]
    ds_read_b64_tr_b16 v[32:33], v213 offset:41088
    v_mfma_f32_16x16x32_bf16 v[252:255], v[152:155], v[10:13], v[252:255]
    ds_read_b64_tr_b16 v[34:35], v213 offset:42368
    buffer_load_dwordx4 v[6:9], v210, s[32:35], s58 offen offset:3072 sc1
    buffer_load_dwordx4 v[10:13], v211, s[32:35], s58 offen offset:3072 sc1
    s_waitcnt vmcnt(8) lgkmcnt(10)
    v_mfma_f32_16x16x32_bf16 v[216:219], v[156:159], v[176:179], v[216:219]
    ds_read_b64_tr_b16 v[36:37], v213 offset:46080
    v_mfma_f32_16x16x32_bf16 v[236:239], v[156:159], v[180:183], v[236:239]
    ds_read_b64_tr_b16 v[38:39], v213 offset:47360
    v_mfma_f32_16x16x32_bf16 v[220:223], v[160:163], v[176:179], v[220:223]
    ds_read_b64_tr_b16 v[40:41], v213 offset:46112
    v_mfma_f32_16x16x32_bf16 v[240:243], v[160:163], v[180:183], v[240:243]
    ds_read_b64_tr_b16 v[42:43], v213 offset:47392
    v_mfma_f32_16x16x32_bf16 v[224:227], v[164:167], v[176:179], v[224:227]
    ds_read_b64_tr_b16 v[44:45], v213 offset:46144
    v_mfma_f32_16x16x32_bf16 v[244:247], v[164:167], v[180:183], v[244:247]
    ds_read_b64_tr_b16 v[46:47], v213 offset:47424
    v_mfma_f32_16x16x32_bf16 v[228:231], v[168:171], v[176:179], v[228:231]
    ds_read_b64_tr_b16 v[48:49], v213 offset:46176
    v_mfma_f32_16x16x32_bf16 v[248:251], v[168:171], v[180:183], v[248:251]
    ds_read_b64_tr_b16 v[50:51], v213 offset:47456
    v_mfma_f32_16x16x32_bf16 v[232:235], v[172:175], v[176:179], v[232:235]
    ds_read_b64_tr_b16 v[52:53], v213 offset:46208
    v_mfma_f32_16x16x32_bf16 v[252:255], v[172:175], v[180:183], v[252:255]
    ds_read_b64_tr_b16 v[54:55], v213 offset:47488
    s_xor_b32 s58, s89, 5
    s_lshl_b32 s58, s58, 12
    buffer_load_dwordx4 v[176:179], v210, s[32:35], s58 offen offset:0 sc1
    buffer_load_dwordx4 v[180:183], v211, s[32:35], s58 offen offset:0 sc1
    s_waitcnt vmcnt(8) lgkmcnt(10)
    v_mfma_f32_16x16x32_bf16 v[216:219], v[16:19], v[184:187], v[216:219]
    ds_read_b64_tr_b16 v[56:57], v213 offset:51200
    v_mfma_f32_16x16x32_bf16 v[236:239], v[16:19], v[188:191], v[236:239]
    ds_read_b64_tr_b16 v[58:59], v213 offset:52480
    v_mfma_f32_16x16x32_bf16 v[220:223], v[20:23], v[184:187], v[220:223]
    ds_read_b64_tr_b16 v[60:61], v213 offset:51232
    v_mfma_f32_16x16x32_bf16 v[240:243], v[20:23], v[188:191], v[240:243]
    ds_read_b64_tr_b16 v[62:63], v213 offset:52512
    v_mfma_f32_16x16x32_bf16 v[224:227], v[24:27], v[184:187], v[224:227]
    ds_read_b64_tr_b16 v[64:65], v213 offset:51264
    v_mfma_f32_16x16x32_bf16 v[244:247], v[24:27], v[188:191], v[244:247]
    ds_read_b64_tr_b16 v[66:67], v213 offset:52544
    v_mfma_f32_16x16x32_bf16 v[228:231], v[28:31], v[184:187], v[228:231]
    ds_read_b64_tr_b16 v[68:69], v213 offset:51296
    v_mfma_f32_16x16x32_bf16 v[248:251], v[28:31], v[188:191], v[248:251]
    ds_read_b64_tr_b16 v[70:71], v213 offset:52576
    v_mfma_f32_16x16x32_bf16 v[232:235], v[32:35], v[184:187], v[232:235]
    ds_read_b64_tr_b16 v[72:73], v213 offset:51328
    v_mfma_f32_16x16x32_bf16 v[252:255], v[32:35], v[188:191], v[252:255]
    ds_read_b64_tr_b16 v[74:75], v213 offset:52608
    buffer_load_dwordx4 v[184:187], v210, s[32:35], s58 offen offset:1024 sc1
    buffer_load_dwordx4 v[188:191], v211, s[32:35], s58 offen offset:1024 sc1
    s_waitcnt vmcnt(8) lgkmcnt(10)
    v_mfma_f32_16x16x32_bf16 v[216:219], v[36:39], v[192:195], v[216:219]
    ds_read_b64_tr_b16 v[76:77], v213 offset:56320
    v_mfma_f32_16x16x32_bf16 v[236:239], v[36:39], v[196:199], v[236:239]
    ds_read_b64_tr_b16 v[78:79], v213 offset:57600
    v_mfma_f32_16x16x32_bf16 v[220:223], v[40:43], v[192:195], v[220:223]
    ds_read_b64_tr_b16 v[80:81], v213 offset:56352
    v_mfma_f32_16x16x32_bf16 v[240:243], v[40:43], v[196:199], v[240:243]
    ds_read_b64_tr_b16 v[82:83], v213 offset:57632
    v_mfma_f32_16x16x32_bf16 v[224:227], v[44:47], v[192:195], v[224:227]
    ds_read_b64_tr_b16 v[84:85], v213 offset:56384
    v_mfma_f32_16x16x32_bf16 v[244:247], v[44:47], v[196:199], v[244:247]
    ds_read_b64_tr_b16 v[86:87], v213 offset:57664
    v_mfma_f32_16x16x32_bf16 v[228:231], v[48:51], v[192:195], v[228:231]
    ds_read_b64_tr_b16 v[88:89], v213 offset:56416
    v_mfma_f32_16x16x32_bf16 v[248:251], v[48:51], v[196:199], v[248:251]
    ds_read_b64_tr_b16 v[90:91], v213 offset:57696
    v_mfma_f32_16x16x32_bf16 v[232:235], v[52:55], v[192:195], v[232:235]
    ds_read_b64_tr_b16 v[92:93], v213 offset:56448
    v_mfma_f32_16x16x32_bf16 v[252:255], v[52:55], v[196:199], v[252:255]
    ds_read_b64_tr_b16 v[94:95], v213 offset:57728
    buffer_load_dwordx4 v[192:195], v210, s[32:35], s58 offen offset:2048 sc1
    buffer_load_dwordx4 v[196:199], v211, s[32:35], s58 offen offset:2048 sc1
    s_waitcnt vmcnt(8) lgkmcnt(10)
    v_mfma_f32_16x16x32_bf16 v[216:219], v[56:59], v[200:203], v[216:219]
    ds_read_b64_tr_b16 v[96:97], v212 offset:40960
    v_mfma_f32_16x16x32_bf16 v[236:239], v[56:59], v[204:207], v[236:239]
    ds_read_b64_tr_b16 v[98:99], v212 offset:42240
    v_mfma_f32_16x16x32_bf16 v[220:223], v[60:63], v[200:203], v[220:223]
    ds_read_b64_tr_b16 v[100:101], v212 offset:40992
    v_mfma_f32_16x16x32_bf16 v[240:243], v[60:63], v[204:207], v[240:243]
    ds_read_b64_tr_b16 v[102:103], v212 offset:42272
    v_mfma_f32_16x16x32_bf16 v[224:227], v[64:67], v[200:203], v[224:227]
    ds_read_b64_tr_b16 v[104:105], v212 offset:41024
    v_mfma_f32_16x16x32_bf16 v[244:247], v[64:67], v[204:207], v[244:247]
    ds_read_b64_tr_b16 v[106:107], v212 offset:42304
    v_mfma_f32_16x16x32_bf16 v[228:231], v[68:71], v[200:203], v[228:231]
    ds_read_b64_tr_b16 v[108:109], v212 offset:41056
    v_mfma_f32_16x16x32_bf16 v[248:251], v[68:71], v[204:207], v[248:251]
    ds_read_b64_tr_b16 v[110:111], v212 offset:42336
    v_mfma_f32_16x16x32_bf16 v[232:235], v[72:75], v[200:203], v[232:235]
    ds_read_b64_tr_b16 v[112:113], v212 offset:41088
    v_mfma_f32_16x16x32_bf16 v[252:255], v[72:75], v[204:207], v[252:255]
    ds_read_b64_tr_b16 v[114:115], v212 offset:42368
    buffer_load_dwordx4 v[200:203], v210, s[32:35], s58 offen offset:3072 sc1
    buffer_load_dwordx4 v[204:207], v211, s[32:35], s58 offen offset:3072 sc1
    s_waitcnt vmcnt(8) lgkmcnt(10)
    v_mfma_f32_16x16x32_bf16 v[216:219], v[76:79], v[6:9], v[216:219]
    ds_read_b64_tr_b16 v[116:117], v212 offset:46080
    v_mfma_f32_16x16x32_bf16 v[236:239], v[76:79], v[10:13], v[236:239]
    ds_read_b64_tr_b16 v[118:119], v212 offset:47360
    v_mfma_f32_16x16x32_bf16 v[220:223], v[80:83], v[6:9], v[220:223]
    ds_read_b64_tr_b16 v[120:121], v212 offset:46112
    v_mfma_f32_16x16x32_bf16 v[240:243], v[80:83], v[10:13], v[240:243]
    ds_read_b64_tr_b16 v[122:123], v212 offset:47392
    v_mfma_f32_16x16x32_bf16 v[224:227], v[84:87], v[6:9], v[224:227]
    ds_read_b64_tr_b16 v[124:125], v212 offset:46144
    v_mfma_f32_16x16x32_bf16 v[244:247], v[84:87], v[10:13], v[244:247]
    ds_read_b64_tr_b16 v[126:127], v212 offset:47424
    v_mfma_f32_16x16x32_bf16 v[228:231], v[88:91], v[6:9], v[228:231]
    ds_read_b64_tr_b16 v[128:129], v212 offset:46176
    v_mfma_f32_16x16x32_bf16 v[248:251], v[88:91], v[10:13], v[248:251]
    ds_read_b64_tr_b16 v[130:131], v212 offset:47456
    v_mfma_f32_16x16x32_bf16 v[232:235], v[92:95], v[6:9], v[232:235]
    ds_read_b64_tr_b16 v[132:133], v212 offset:46208
    v_mfma_f32_16x16x32_bf16 v[252:255], v[92:95], v[10:13], v[252:255]
    ds_read_b64_tr_b16 v[134:135], v212 offset:47488
    s_waitcnt vmcnt(6) lgkmcnt(10)
    v_mfma_f32_16x16x32_bf16 v[216:219], v[96:99], v[176:179], v[216:219]
    ds_read_b64_tr_b16 v[136:137], v212 offset:51200
    v_mfma_f32_16x16x32_bf16 v[236:239], v[96:99], v[180:183], v[236:239]
    ds_read_b64_tr_b16 v[138:139], v212 offset:52480
    v_mfma_f32_16x16x32_bf16 v[220:223], v[100:103], v[176:179], v[220:223]
    ds_read_b64_tr_b16 v[140:141], v212 offset:51232
    v_mfma_f32_16x16x32_bf16 v[240:243], v[100:103], v[180:183], v[240:243]
    ds_read_b64_tr_b16 v[142:143], v212 offset:52512
    v_mfma_f32_16x16x32_bf16 v[224:227], v[104:107], v[176:179], v[224:227]
    ds_read_b64_tr_b16 v[144:145], v212 offset:51264
    v_mfma_f32_16x16x32_bf16 v[244:247], v[104:107], v[180:183], v[244:247]
    ds_read_b64_tr_b16 v[146:147], v212 offset:52544
    v_mfma_f32_16x16x32_bf16 v[228:231], v[108:111], v[176:179], v[228:231]
    ds_read_b64_tr_b16 v[148:149], v212 offset:51296
    v_mfma_f32_16x16x32_bf16 v[248:251], v[108:111], v[180:183], v[248:251]
    ds_read_b64_tr_b16 v[150:151], v212 offset:52576
    v_mfma_f32_16x16x32_bf16 v[232:235], v[112:115], v[176:179], v[232:235]
    ds_read_b64_tr_b16 v[152:153], v212 offset:51328
    v_mfma_f32_16x16x32_bf16 v[252:255], v[112:115], v[180:183], v[252:255]
    ds_read_b64_tr_b16 v[154:155], v212 offset:52608
    s_mul_i32 s46, s38, 5120
    v_add_u32 v2, s46, v214
    s_xor_b32 s47, s38, 2
    s_mul_i32 s47, s47, 5120
    v_add_u32 v3, s47, v214
    v_bfe_u32 v4, v1, 4, 1
    v_mul_u32_u24 v4, 24, v4
    v_add_u32 v4, v4, v215
    s_waitcnt vmcnt(4) lgkmcnt(10)
    v_mfma_f32_16x16x32_bf16 v[216:219], v[116:119], v[184:187], v[216:219]
    ds_read_b64_tr_b16 v[156:157], v212 offset:56320
    v_mfma_f32_16x16x32_bf16 v[236:239], v[116:119], v[188:191], v[236:239]
    ds_read_b64_tr_b16 v[158:159], v212 offset:57600
    v_mfma_f32_16x16x32_bf16 v[220:223], v[120:123], v[184:187], v[220:223]
    ds_read_b64_tr_b16 v[160:161], v212 offset:56352
    v_mfma_f32_16x16x32_bf16 v[240:243], v[120:123], v[188:191], v[240:243]
    ds_read_b64_tr_b16 v[162:163], v212 offset:57632
    v_mfma_f32_16x16x32_bf16 v[224:227], v[124:127], v[184:187], v[224:227]
    ds_read_b64_tr_b16 v[164:165], v212 offset:56384
    v_mfma_f32_16x16x32_bf16 v[244:247], v[124:127], v[188:191], v[244:247]
    ds_read_b64_tr_b16 v[166:167], v212 offset:57664
    v_mfma_f32_16x16x32_bf16 v[228:231], v[128:131], v[184:187], v[228:231]
    ds_read_b64_tr_b16 v[168:169], v212 offset:56416
    v_mfma_f32_16x16x32_bf16 v[248:251], v[128:131], v[188:191], v[248:251]
    ds_read_b64_tr_b16 v[170:171], v212 offset:57696
    v_mfma_f32_16x16x32_bf16 v[232:235], v[132:135], v[184:187], v[232:235]
    ds_read_b64_tr_b16 v[172:173], v212 offset:56448
    v_mfma_f32_16x16x32_bf16 v[252:255], v[132:135], v[188:191], v[252:255]
    ds_read_b64_tr_b16 v[174:175], v212 offset:57728
    s_waitcnt vmcnt(2) lgkmcnt(10)
    v_mfma_f32_16x16x32_bf16 v[216:219], v[136:139], v[192:195], v[216:219]
    v_mfma_f32_16x16x32_bf16 v[220:223], v[140:143], v[192:195], v[220:223]
    v_mfma_f32_16x16x32_bf16 v[224:227], v[144:147], v[192:195], v[224:227]
    v_mfma_f32_16x16x32_bf16 v[228:231], v[148:151], v[192:195], v[228:231]
    v_mfma_f32_16x16x32_bf16 v[232:235], v[152:155], v[192:195], v[232:235]
    s_waitcnt vmcnt(0) lgkmcnt(0)
    s_barrier
    v_mfma_f32_16x16x32_bf16 v[216:219], v[156:159], v[200:203], v[216:219]
    v_mfma_f32_16x16x32_bf16 v[220:223], v[160:163], v[200:203], v[220:223]
    v_mfma_f32_16x16x32_bf16 v[224:227], v[164:167], v[200:203], v[224:227]
    v_mfma_f32_16x16x32_bf16 v[228:231], v[168:171], v[200:203], v[228:231]
    v_mfma_f32_16x16x32_bf16 v[232:235], v[172:175], v[200:203], v[232:235]
    v_mfma_f32_16x16x32_bf16 v[236:239], v[136:139], v[196:199], v[236:239]
    v_mfma_f32_16x16x32_bf16 v[240:243], v[140:143], v[196:199], v[240:243]
    v_mfma_f32_16x16x32_bf16 v[244:247], v[144:147], v[196:199], v[244:247]
    v_mfma_f32_16x16x32_bf16 v[248:251], v[148:151], v[196:199], v[248:251]
    v_mfma_f32_16x16x32_bf16 v[252:255], v[152:155], v[196:199], v[252:255]
    ds_write_b128 v3, v[216:219] offset:0
    v_mfma_f32_16x16x32_bf16 v[236:239], v[156:159], v[204:207], v[236:239]
    ds_write_b128 v3, v[220:223] offset:1024
    v_mfma_f32_16x16x32_bf16 v[240:243], v[160:163], v[204:207], v[240:243]
    ds_write_b128 v3, v[224:227] offset:2048
    v_mfma_f32_16x16x32_bf16 v[244:247], v[164:167], v[204:207], v[244:247]
    ds_write_b128 v3, v[228:231] offset:3072
    v_mfma_f32_16x16x32_bf16 v[248:251], v[168:171], v[204:207], v[248:251]
    ds_write_b128 v3, v[232:235] offset:4096
    v_mfma_f32_16x16x32_bf16 v[252:255], v[172:175], v[204:207], v[252:255]
    s_waitcnt lgkmcnt(0)
    s_barrier
    ds_read_b128 v[16:19], v2 offset:0
    ds_read_b128 v[20:23], v2 offset:1024
    ds_read_b128 v[24:27], v2 offset:2048
    ds_read_b128 v[28:31], v2 offset:3072
    ds_read_b128 v[32:35], v2 offset:4096
    s_waitcnt lgkmcnt(4)
    v_add_f32 v16, v16, v236
    v_add_f32 v17, v17, v237
    v_add_f32 v18, v18, v238
    v_add_f32 v19, v19, v239
    v_cvt_pk_bf16_f32 v40, v16, v17
    v_cvt_pk_bf16_f32 v41, v18, v19
    s_waitcnt lgkmcnt(3)
    v_add_f32 v20, v20, v240
    v_add_f32 v21, v21, v241
    v_add_f32 v22, v22, v242
    v_add_f32 v23, v23, v243
    v_cvt_pk_bf16_f32 v42, v20, v21
    v_cvt_pk_bf16_f32 v43, v22, v23
    s_nop 1
    v_permlane16_swap_b32 v40, v42
    v_permlane16_swap_b32 v41, v43
    buffer_store_dwordx4 v[40:43], v4, s[68:71], 0 offen offset:0
    s_waitcnt lgkmcnt(2)
    v_add_f32 v24, v24, v244
    v_add_f32 v25, v25, v245
    v_add_f32 v26, v26, v246
    v_add_f32 v27, v27, v247
    v_cvt_pk_bf16_f32 v44, v24, v25
    v_cvt_pk_bf16_f32 v45, v26, v27
    s_waitcnt lgkmcnt(1)
    v_add_f32 v28, v28, v248
    v_add_f32 v29, v29, v249
    v_add_f32 v30, v30, v250
    v_add_f32 v31, v31, v251
    v_cvt_pk_bf16_f32 v46, v28, v29
    v_cvt_pk_bf16_f32 v47, v30, v31
    s_nop 1
    v_permlane16_swap_b32 v44, v46
    v_permlane16_swap_b32 v45, v47
    buffer_store_dwordx4 v[44:47], v4, s[68:71], 0 offen offset:64
    s_waitcnt lgkmcnt(0)
    v_add_f32 v32, v32, v252
    v_add_f32 v33, v33, v253
    v_add_f32 v34, v34, v254
    v_add_f32 v35, v35, v255
    v_cvt_pk_bf16_f32 v48, v32, v33
    v_cvt_pk_bf16_f32 v49, v34, v35
    buffer_store_dwordx2 v[48:49], v215, s[68:71], 0 offen offset:128
L_fin:
    s_endpgm
L_codeend:
.section .rodata,"a"
.p2align 6
.amdhsa_kernel standalone__glu_gated_glu__prompt_kernel
  .amdhsa_next_free_vgpr 256
  .amdhsa_next_free_sgpr 100
  .amdhsa_accum_offset 256
  .amdhsa_group_segment_fixed_size 0
  .amdhsa_kernarg_size 56
  .amdhsa_user_sgpr_count 2
  .amdhsa_user_sgpr_kernarg_segment_ptr 1
  .amdhsa_system_sgpr_workgroup_id_x 1
.end_amdhsa_kernel
```
